```python
import torch

def _softmax(x, axis=-1):
    return torch.softmax(x, dim=axis)
def _gelu(x):
    return torch.nn.functional.gelu(x, approximate="tanh")
def _silu(x):
    return torch.nn.functional.silu(x)
def _sigmoid(x):
    return torch.sigmoid(x)
def _layernorm(x, axis=-1, eps=1e-5):
    m = x.mean(dim=axis, keepdim=True)
    v = x.var(dim=axis, keepdim=True, unbiased=False)
    return (x - m) / torch.sqrt(v + eps)
def _scatter_add(tgt, idx, src, axis=0):
    return tgt.clone().index_add_(axis, idx, src)
def _segment_sum(src, seg, n):
    out = torch.zeros((n,) + src.shape[1:], dtype=src.dtype)
    return out.index_add_(0, seg, src)
def _pad(x, pw):
    flat = tuple(v for pair in reversed(pw) for v in pair)
    return torch.nn.functional.pad(x, flat)

kernel_name = 'sequential_preLN__spectral_gfnet__glu_gated_bilinear__prompt'

def setup_inputs():

    _w = (lambda a: (lambda t: t.to(torch.bfloat16) if t.is_floating_point() else t)(torch.as_tensor(a)))
    def _A_setup():
        B, S, D = 1, 2048, 448
        Df = D // 2 + 1
        return {
            "x": _w((lambda *s: torch.randn(*s, dtype=torch.bfloat16) * 0.05)(B, S, D)),
            "w_r": _w((lambda *s: torch.randn(*s, dtype=torch.bfloat16) * 0.4)(S, Df) * 0.02),
            "w_i": _w((lambda *s: torch.randn(*s, dtype=torch.bfloat16) * 0.4)(S, Df) * 0.02),
        }
    _A_in = _A_setup()

    def _B_setup():
        B, S, D, F = 1, 2048, 448, 1792
        return {
            "x": _w((lambda *s: torch.randn(*s, dtype=torch.bfloat16) * 0.05)(B, S, D)),
            "w_gate": _w((lambda *s: torch.randn(*s, dtype=torch.bfloat16) * 0.2)(D, F) * (D ** -0.5)),
            "w_up": _w((lambda *s: torch.randn(*s, dtype=torch.bfloat16) * 0.2)(D, F) * (D ** -0.5)),
            "w_down": _w((lambda *s: torch.randn(*s, dtype=torch.bfloat16) * 0.2)(F, D) * (F ** -0.5)),
        }
    _B_in = _B_setup()

    return {
        "A_x": _A_in["x"],
        "A_w_r": _A_in["w_r"],
        "A_w_i": _A_in["w_i"],
        "B_x": _B_in["x"],
        "B_w_gate": _B_in["w_gate"],
        "B_w_up": _B_in["w_up"],
        "B_w_down": _B_in["w_down"],
    }

def reference(A_x, A_w_r, A_w_i, B_x, B_w_gate, B_w_up, B_w_down):
    def _A_ref(x, w_r, w_i):
        B, S, D = x.shape
        X = (lambda x, axes=(-2,-1): torch.fft.rfft2(x.float(), dim=axes))(x, axes=(-2, -1))
        W = w_r + 1j * w_i
        X = X * W
        y = (lambda x, s, axes=(-2,-1): torch.fft.irfft2(x, s=s, dim=axes).to(torch.bfloat16))(X, (S, D), axes=(-2, -1))
        return y

    def _B_ref(x, w_gate, w_up, w_down):
        g = torch.einsum("bsd,df->bsf", x, w_gate)
        u = torch.einsum("bsd,df->bsf", x, w_up)
        h = g * u
        return torch.einsum("bsf,fd->bsd", h, w_down)

    x = A_x
    h = x + _A_ref(_layernorm(x, axis=-1), A_w_r, A_w_i)
    h2 = h + _B_ref(_layernorm(h, axis=-1), B_w_gate, B_w_up, B_w_down)
    return h2
```

```asm
; @launch grid=(256,1,1) block=(256,1,1) lds=163840
.amdgcn_target "amdgcn-amd-amdhsa--gfx950"
.text
.globl sequential_preLN__spectral_gfnet__glu_gated_bilinear__prompt_kernel
.p2align 8
.type sequential_preLN__spectral_gfnet__glu_gated_bilinear__prompt_kernel,@function
sequential_preLN__spectral_gfnet__glu_gated_bilinear__prompt_kernel:
    s_cmp_ge_u32 s2, 256
    s_cbranch_scc1 L_end
    s_load_dwordx2 s[8:9], s[0:1], 0
    s_load_dwordx2 s[4:5], s[0:1], 72
    s_load_dwordx2 s[12:13], s[0:1], 8
    s_load_dwordx2 s[16:17], s[0:1], 16
    s_load_dwordx8 s[36:43], s[0:1], 32
    s_and_b32 s44, s2, 7
    s_lshr_b32 s45, s2, 3
    s_getpc_b64 s[48:49]
    s_min_u32 s3, s45, 28
    s_lshl_b32 s3, s3, 10
    v_and_b32 v48, 7, v0
    v_lshl_add_u32 v48, v48, 7, s3
    v_mov_b32 v51, s49
    v_add_co_u32 v50, vcc, s48, v48
    s_nop 1
    v_addc_co_u32 v51, vcc, 0, v51, vcc
    global_load_dword v3, v[50:51], off
    s_mov_b32 s10, 1835008
    s_mov_b32 s11, 0x20000
    v_lshrrev_b32 v48, 6, v0
    v_and_b32 v46, 31, v0
    v_readfirstlane_b32 s46, v48
    v_bfe_u32 v48, v0, 5, 1
    v_mul_u32_u24 v48, 28672, v48
    v_lshl_add_u32 v49, v46, 2, v48
    s_lshl_b32 s48, s44, 2
    s_add_u32 s48, s48, s46
    s_lshl_b32 s48, s48, 6
    s_add_u32 s48, s48, s45
    s_mul_i32 s48, s48, 896
    s_waitcnt lgkmcnt(0)
    buffer_load_dword v50, v49, s[8:11], s48 offen offset:0
    buffer_load_dword v51, v49, s[8:11], s48 offen offset:128
    buffer_load_dword v52, v49, s[8:11], s48 offen offset:256
    buffer_load_dword v53, v49, s[8:11], s48 offen offset:384
    buffer_load_dword v54, v49, s[8:11], s48 offen offset:512
    buffer_load_dword v55, v49, s[8:11], s48 offen offset:640
    buffer_load_dword v56, v49, s[8:11], s48 offen offset:768
    s_mov_b32 s6, 25165824
    s_mov_b32 s7, 0x20000
    s_lshl_b32 s47, s44, 5
    s_add_u32 s47, s47, s45
    s_mul_i32 s49, s47, 8448
    s_add_u32 s50, s49, 22020096
    v_lshlrev_b32 v47, 4, v0
    v_add_u32 v57, 4096, v47
    v_mov_b32 v4, -1
    v_mov_b32 v5, -1
    v_mov_b32 v6, -1
    v_mov_b32 v7, -1
    buffer_store_dwordx4 v[4:7], v47, s[4:7], s50 offen sc1
    buffer_store_dwordx4 v[4:7], v57, s[4:7], s50 offen sc1
    v_and_b32 v1, 63, v0
    v_and_b32 v44, 15, v0
    v_bfe_u32 v45, v0, 4, 2
    s_lshr_b32 s53, s47, 2
    s_and_b32 s53, s53, 48
    s_and_b32 s3, s47, 3
    s_lshl2_add_u32 s53, s3, s53
    s_and_b32 s3, s47, 12
    s_lshl_b32 s3, s3, 6
    s_add_u32 s53, s53, s3
    s_and_b32 s3, s46, 2
    s_lshl_b32 s3, s3, 9
    s_add_u32 s53, s53, s3
    s_bfe_u32 s3, s47, 0x20004
    s_mul_i32 s54, s3, 224
    s_sub_u32 s3, 672, s54
    s_bitcmp1_b32 s47, 5
    s_cselect_b32 s54, s3, s54
    s_cselect_b32 s52, -1, 1
    v_add_u32 v48, s53, v45
    v_mul_lo_u32 v48, v48, s52
    s_lshl_b32 s52, s52, 6
    s_movk_i32 s53, 450
    v_lshl_add_u32 v62, v45, 1, v44
    v_and_b32 v62, 15, v62
    v_lshlrev_b32 v62, 4, v62
    v_and_b32 v58, 1, v45
    v_lshlrev_b32 v58, 1, v58
    v_sub_u32 v62, v62, v58
    s_mov_b32 s14, 921600
    s_mov_b32 s15, 0x20000
    s_bitcmp1_b32 s46, 0
    s_cselect_b64 s[12:13], s[16:17], s[12:13]
    s_lshl_b32 s3, s46, 12
    s_add_u32 m0, s3, 139264
    v_and_b32 v58, 2047, v48
    v_mad_u32_u24 v58, v58, s53, v62
    buffer_load_dwordx4 v58, s[12:15], s54 offen lds
    s_add_u32 m0, m0, 1024
    v_add_u32 v48, s52, v48
    v_and_b32 v59, 2047, v48
    v_mad_u32_u24 v59, v59, s53, v62
    buffer_load_dwordx4 v59, s[12:15], s54 offen lds
    s_add_u32 m0, m0, 1024
    v_add_u32 v48, s52, v48
    v_and_b32 v60, 2047, v48
    v_mad_u32_u24 v60, v60, s53, v62
    buffer_load_dwordx4 v60, s[12:15], s54 offen lds
    s_add_u32 m0, m0, 1024
    v_add_u32 v48, s52, v48
    v_and_b32 v61, 2047, v48
    v_mad_u32_u24 v61, v61, s53, v62
    buffer_load_dwordx4 v61, s[12:15], s54 offen lds
    s_add_u32 s52, s4, 15728640
    s_addc_u32 s53, s5, 0
    s_load_dword s54, s[52:53], 393216
    v_lshlrev_b32 v2, 4, v1
    s_add_u32 s51, s49, 18874368
    s_lshl_b32 s3, s46, 4
    v_add_u32 v62, s3, v44
    s_mov_b64 s[20:21], s[36:37]
    s_mov_b32 s22, 1605632
    s_mov_b32 s23, 0x20000
    s_mov_b64 s[24:25], s[38:39]
    s_mov_b32 s26, 1605632
    s_mov_b32 s27, 0x20000
    s_mov_b64 s[28:29], s[40:41]
    s_mov_b32 s30, 1605632
    s_mov_b32 s31, 0x20000
    s_mov_b64 s[32:33], s[42:43]
    s_mov_b32 s34, 1835008
    s_mov_b32 s35, 0x20000
    s_bitcmp1_b32 s46, 0
    s_cselect_b32 s8, s24, s20
    s_cselect_b32 s9, s25, s21
    s_mov_b32 s10, 1605632
    s_mov_b32 s11, 0x20000
    s_mul_i32 s3, s44, 28
    s_add_u32 s12, s3, 27
    s_lshr_b32 s12, s12, 4
    s_lshr_b32 s3, s3, 4
    s_sub_u32 s12, s12, s3
    s_lshl_b32 s12, s12, 1
    s_add_u32 s12, s12, 2
    v_lshrrev_b32 v48, 3, v1
    v_mul_u32_u24 v48, 3584, v48
    v_and_b32 v49, 7, v1
    v_cmp_gt_u32 vcc, s12, v49
    v_lshl_add_u32 v48, v49, 7, v48
    v_mov_b32 v49, 2130706432
    v_cndmask_b32 v58, v49, v48, vcc
    s_lshl_b32 s3, s3, 8
    s_lshr_b32 s12, s46, 1
    s_add_u32 s12, s12, s45
    s_add_u32 s12, s12, s45
    s_mul_i32 s12, s12, 14336
    s_add_u32 s12, s3, s12
    s_add_u32 s3, s12, 0
    s_mov_b32 exec_hi, 0
    buffer_load_dword v3, v58, s[8:11], s3 offen
    s_mov_b64 exec, -1
    v_lshrrev_b32 v61, 5, v1
    s_lshl_b32 s3, s46, 1
    v_add_u32 v61, s3, v61
    v_mov_b32 v65, v61
    v_bfe_u32 v63, v46, 1, 2
    v_xor_b32 v61, v61, v63
    v_bfe_u32 v63, v46, 3, 1
    v_mul_u32_u24 v63, 12, v63
    v_xor_b32 v61, v61, v63
    v_lshlrev_b32 v61, 4, v61
    v_lshrrev_b32 v63, 1, v46
    v_lshl_add_u32 v61, v63, 8, v61
    v_and_b32 v63, 1, v46
    v_lshl_add_u32 v61, v63, 3, v61
    v_add_u32 v48, 114688, v61
    v_xor_b32 v49, 128, v48
    v_xor_b32 v61, v44, v45
    v_lshlrev_b32 v61, 4, v61
    v_lshl_add_u32 v61, v45, 8, v61
    v_add_u32 v59, 114688, v61
    v_xor_b32 v60, 192, v59
    v_lshlrev_b32 v61, 4, v45
    v_lshl_add_u32 v61, v44, 6, v61
    s_lshl_b32 s3, s46, 10
    v_add_u32 v64, s3, v61
    v_and_b32 v115, 1, v1
    v_mul_u32_u24 v115, 0x8000, v115
    v_lshl_or_b32 v115, v115, 16, v115
    v_lshlrev_b32 v116, 2, v45
    v_cvt_f32_u32 v116, v116
    v_lshlrev_b32 v110, 1, v46
    v_cvt_f32_u32 v110, v110
    v_add_f32 v111, 1.0, v110
    v_mul_f32 v112, 0x3b124925, v110
    v_cos_f32 v98, v112
    v_sin_f32 v104, v112
    v_mul_f32 v112, 0x3b124925, v111
    v_cos_f32 v99, v112
    v_sin_f32 v105, v112
    v_mul_f32 v112, 0x3b924925, v110
    v_cos_f32 v100, v112
    v_sin_f32 v106, v112
    v_mul_f32 v112, 0x3b924925, v111
    v_cos_f32 v101, v112
    v_sin_f32 v107, v112
    v_mul_f32 v112, 0x3bdb6db7, v110
    v_cos_f32 v102, v112
    v_sin_f32 v108, v112
    v_mul_f32 v112, 0x3bdb6db7, v111
    v_cos_f32 v103, v112
    v_sin_f32 v109, v112
    s_mov_b32 s14, 0x3f1f9d07
    s_mov_b32 s15, 0x3f48261c
    s_mov_b32 s16, 0xbe63dc87
    s_mov_b32 s17, 0x3f7994e0
    s_mov_b32 s18, 0xbf66a5e5
    s_mov_b32 s19, 0x3ede2602
    v_cvt_f32_u32 v110, v62
    v_mul_f32 v110, 0x3c800000, v110
    v_mul_f32 v111, v110, v116
    s_waitcnt vmcnt(7)
    v_lshlrev_b32 v136, 16, v50
    v_and_b32 v137, 0xffff0000, v50
    v_lshlrev_b32 v138, 16, v51
    v_and_b32 v139, 0xffff0000, v51
    v_pk_mul_f32 v[170:171], v[136:137], v[136:137]
    v_lshlrev_b32 v140, 16, v52
    v_and_b32 v141, 0xffff0000, v52
    v_pk_fma_f32 v[170:171], v[138:139], v[138:139], v[170:171]
    v_lshlrev_b32 v142, 16, v53
    v_and_b32 v143, 0xffff0000, v53
    v_pk_fma_f32 v[170:171], v[140:141], v[140:141], v[170:171]
    v_lshlrev_b32 v144, 16, v54
    v_and_b32 v145, 0xffff0000, v54
    v_lshlrev_b32 v146, 16, v55
    v_and_b32 v147, 0xffff0000, v55
    v_lshlrev_b32 v148, 16, v56
    v_and_b32 v149, 0xffff0000, v56
    v_pk_fma_f32 v[170:171], v[142:143], v[142:143], v[170:171]
    v_pk_add_f32 v[50:51], v[138:139], v[148:149]
    v_pk_add_f32 v[52:53], v[140:141], v[146:147]
    v_pk_add_f32 v[54:55], v[142:143], v[144:145]
    v_pk_fma_f32 v[170:171], v[144:145], v[144:145], v[170:171]
    v_pk_add_f32 v[156:157], v[136:137], v[50:51]
    v_pk_add_f32 v[172:173], v[52:53], v[54:55]
    v_pk_fma_f32 v[170:171], v[146:147], v[146:147], v[170:171]
    v_pk_fma_f32 v[170:171], v[148:149], v[148:149], v[170:171]
    v_pk_add_f32 v[156:157], v[156:157], v[172:173]
    v_add_f32 v119, v170, v171
    v_add_f32 v56, v156, v157
    v_pk_add_f32 v[150:151], v[138:139], v[148:149] neg_lo:[0,1] neg_hi:[0,1]
    v_add_f32_dpp v119, v119, v119 row_ror:8 row_mask:0xf bank_mask:0xf
    v_add_f32_dpp v56, v56, v56 row_ror:8 row_mask:0xf bank_mask:0xf
    v_pk_add_f32 v[152:153], v[140:141], v[146:147] neg_lo:[0,1] neg_hi:[0,1]
    v_add_f32_dpp v119, v119, v119 row_ror:4 row_mask:0xf bank_mask:0xf
    v_add_f32_dpp v56, v56, v56 row_ror:4 row_mask:0xf bank_mask:0xf
    v_pk_fma_f32 v[158:159], v[50:51], s[14:15], v[136:137] op_sel_hi:[1,0,1]
    v_add_f32_dpp v119, v119, v119 row_ror:2 row_mask:0xf bank_mask:0xf
    v_add_f32_dpp v56, v56, v56 row_ror:2 row_mask:0xf bank_mask:0xf
    v_pk_mul_f32 v[164:165], v[150:151], s[14:15] op_sel:[0,1] neg_lo:[0,1] neg_hi:[0,1]
    v_add_f32_dpp v119, v119, v119 row_ror:1 row_mask:0xf bank_mask:0xf
    v_add_f32_dpp v56, v56, v56 row_ror:1 row_mask:0xf bank_mask:0xf
    v_mov_b32 v61, v56
    v_mov_b32 v63, v119
    v_pk_add_f32 v[154:155], v[142:143], v[144:145] neg_lo:[0,1] neg_hi:[0,1]
    v_permlane16_swap_b32 v56, v61
    v_permlane16_swap_b32 v119, v63
    v_add_f32 v56, v56, v61
    v_add_f32 v119, v119, v63
    v_mul_f32 v56, 0x3b124925, v56
    v_mul_f32 v119, 0x3b124925, v119
    v_fma_f32 v119, -v56, v56, v119
    v_max_f32 v119, 0, v119
    v_cvt_pk_bf16_f32 v119, 0, v119
    v_add_f32 v119, 0x3727c5ac, v119
    v_cvt_pk_bf16_f32 v119, 0, v119
    v_pk_fma_f32 v[158:159], v[52:53], s[16:17], v[158:159] op_sel_hi:[1,0,1]
    v_pk_fma_f32 v[164:165], v[152:153], s[16:17], v[164:165] op_sel:[0,1,0] neg_lo:[0,1,0] neg_hi:[0,1,0]
    v_sqrt_f32 v119, v119
    v_pk_fma_f32 v[158:159], v[54:55], s[18:19], v[158:159] op_sel_hi:[1,0,1]
    v_pk_fma_f32 v[164:165], v[154:155], s[18:19], v[164:165] op_sel:[0,1,0] neg_lo:[0,1,0] neg_hi:[0,1,0]
    v_pk_fma_f32 v[160:161], v[50:51], s[16:17], v[136:137] op_sel_hi:[1,0,1]
    v_pk_mul_f32 v[166:167], v[150:151], s[16:17] op_sel:[0,1] neg_lo:[0,1] neg_hi:[0,1]
    v_pk_fma_f32 v[160:161], v[52:53], s[18:19], v[160:161] op_sel_hi:[1,0,1]
    v_pk_fma_f32 v[166:167], v[152:153], s[18:19], v[166:167] op_sel:[0,1,0]
    v_pk_mul_f32 v[172:173], v[164:165], v[104:105]
    v_pk_mul_f32 v[174:175], v[158:159], v[104:105]
    v_pk_fma_f32 v[160:161], v[54:55], s[14:15], v[160:161] op_sel_hi:[1,0,1]
    v_pk_fma_f32 v[166:167], v[154:155], s[14:15], v[166:167] op_sel:[0,1,0]
    v_pk_fma_f32 v[162:163], v[50:51], s[18:19], v[136:137] op_sel_hi:[1,0,1]
    v_pk_mul_f32 v[168:169], v[150:151], s[18:19] op_sel:[0,1] neg_lo:[0,1] neg_hi:[0,1]
    v_pk_fma_f32 v[158:159], v[158:159], v[98:99], v[172:173]
    v_pk_fma_f32 v[164:165], v[164:165], v[98:99], v[174:175] neg_lo:[0,0,1] neg_hi:[0,0,1]
    v_cvt_pk_bf16_f32 v119, 0, v119
    v_pk_fma_f32 v[162:163], v[52:53], s[14:15], v[162:163] op_sel_hi:[1,0,1]
    v_pk_fma_f32 v[168:169], v[152:153], s[14:15], v[168:169] op_sel:[0,1,0]
    v_pk_mul_f32 v[172:173], v[166:167], v[106:107]
    v_pk_mul_f32 v[174:175], v[160:161], v[106:107]
    v_rcp_f32 v177, v119
    v_pk_fma_f32 v[162:163], v[54:55], s[16:17], v[162:163] op_sel_hi:[1,0,1]
    v_pk_fma_f32 v[168:169], v[154:155], s[16:17], v[168:169] op_sel:[0,1,0] neg_lo:[0,1,0] neg_hi:[0,1,0]
    v_pk_fma_f32 v[160:161], v[160:161], v[100:101], v[172:173]
    v_pk_fma_f32 v[166:167], v[166:167], v[100:101], v[174:175] neg_lo:[0,0,1] neg_hi:[0,0,1]
    v_cvt_pk_bf16_f32 v176, 0, v56
    v_pk_mul_f32 v[172:173], v[168:169], v[108:109]
    v_pk_mul_f32 v[174:175], v[162:163], v[108:109]
    v_pk_fma_f32 v[162:163], v[162:163], v[102:103], v[172:173]
    v_mul_f32 v176, 0xc0e00000, v176
    v_pk_fma_f32 v[168:169], v[168:169], v[102:103], v[174:175] neg_lo:[0,0,1] neg_hi:[0,0,1]
    v_mul_f32 v172, 0x36124925, v177
    v_mov_b32 v173, v176
    v_mul_f32 v174, 0x35924925, v177
    v_pk_add_f32 v[156:157], v[156:157], v[172:173] op_sel:[0,1]
    v_pk_mul_f32 v[156:157], v[156:157], v[174:175] op_sel_hi:[1,0]
    v_pk_mul_f32 v[158:159], v[158:159], v[172:173] op_sel_hi:[1,0]
    v_pk_mul_f32 v[164:165], v[164:165], v[172:173] op_sel_hi:[1,0]
    v_cvt_pk_bf16_f32 v50, v156, 0
    v_cvt_pk_bf16_f32 v51, v157, 0
    v_pk_mul_f32 v[160:161], v[160:161], v[172:173] op_sel_hi:[1,0]
    v_pk_mul_f32 v[166:167], v[166:167], v[172:173] op_sel_hi:[1,0]
    ds_write_b64 v48, v[50:51] offset:0
    v_cvt_pk_bf16_f32 v52, v158, v164
    v_cvt_pk_bf16_f32 v53, v159, v165
    v_pk_mul_f32 v[162:163], v[162:163], v[172:173] op_sel_hi:[1,0]
    v_pk_mul_f32 v[168:169], v[168:169], v[172:173] op_sel_hi:[1,0]
    ds_write_b64 v49, v[52:53] offset:0
    v_cvt_pk_bf16_f32 v54, v160, v166
    v_cvt_pk_bf16_f32 v55, v161, v167
    ds_write_b64 v48, v[54:55] offset:4096
    v_cvt_pk_bf16_f32 v150, v162, v168
    v_cvt_pk_bf16_f32 v151, v163, v169
    ds_write_b64 v49, v[150:151] offset:4096
    v_lshrrev_b32 v118, 4, v0
    v_mul_u32_u24 v118, 7, v118
    v_bfe_u32 v61, v0, 2, 2
    v_add_u32 v118, v118, v61
    v_sub_u32 v61, 112, v118
    s_bitcmp1_b32 s47, 5
    s_cselect_b64 vcc, -1, 0
    s_cselect_b32 s36, 0x80000000, 0
    v_cndmask_b32 v118, v118, v61, vcc
    v_and_b32 v61, 1, v0
    v_add_u32 v118, v118, v61
    v_and_b32 v61, 3, v0
    v_lshlrev_b32 v63, 4, v61
    v_sub_u32 v118, v118, v63
    v_lshlrev_b32 v118, 1, v118
    v_and_b32 v118, 255, v118
    v_lshl_add_u32 v118, v61, 8, v118
    v_add_u32 v118, 139264, v118
    v_mov_b32 v180, 0
    v_mov_b32 v181, 0
    v_mov_b32 v182, 0
    v_mov_b32 v183, 0
    v_and_b32 v179, 0x70, v2
    v_lshrrev_b32 v178, 3, v1
    v_lshl_add_u32 v178, v178, 15, v179
    s_lshl_b32 s3, s47, 7
    s_add_u32 s3, s3, 16252928
    s_cmp_eq_u32 s46, 0
    s_cselect_b32 s3, s3, 2130706432
    buffer_store_dwordx4 v[180:183], v178, s[4:7], s3 offen sc1
    s_sub_u32 s3, s3, 524288
    s_mov_b64 exec, 0xff
    buffer_store_dwordx4 v[180:183], v179, s[4:7], s3 offen sc1
    s_mov_b64 exec, -1
    s_mul_i32 s3, s45, 37
    s_lshr_b32 s3, s3, 8
    s_mul_i32 s40, s3, 7
    s_sub_u32 s40, s45, s40
    s_lshl_b32 s39, s44, 2
    s_add_u32 s39, s39, s3
    s_mul_i32 s3, s44, 28
    s_add_u32 s3, s3, s45
    s_lshr_b32 s38, s3, 4
    s_and_b32 s37, s3, 15
    s_cmp_lt_u32 s45, 28
    s_cselect_b32 s22, s22, 0
    s_cselect_b32 s26, s26, 0
    v_fmamk_f32 v112, v110, 0x00000000, v111
    v_cos_f32 v113, v112
    v_sin_f32 v114, v112
    s_nop 0
    v_cvt_pk_bf16_f32 v66, v113, v114
    v_cvt_pk_bf16_f32 v82, -v114, v113
    v_xor_b32 v74, v115, v66
    v_xor_b32 v90, v115, v82
    v_fmamk_f32 v112, v110, 0x3f800000, v111
    v_cos_f32 v113, v112
    v_sin_f32 v114, v112
    s_nop 0
    v_cvt_pk_bf16_f32 v67, v113, v114
    v_cvt_pk_bf16_f32 v83, -v114, v113
    v_xor_b32 v75, v115, v67
    v_xor_b32 v91, v115, v83
    v_fmamk_f32 v112, v110, 0x40000000, v111
    v_cos_f32 v113, v112
    v_sin_f32 v114, v112
    s_nop 0
    v_cvt_pk_bf16_f32 v68, v113, v114
    v_cvt_pk_bf16_f32 v84, -v114, v113
    v_xor_b32 v76, v115, v68
    v_xor_b32 v92, v115, v84
    v_fmamk_f32 v112, v110, 0x40400000, v111
    v_cos_f32 v113, v112
    v_sin_f32 v114, v112
    s_nop 0
    v_cvt_pk_bf16_f32 v69, v113, v114
    v_cvt_pk_bf16_f32 v85, -v114, v113
    v_xor_b32 v77, v115, v69
    v_xor_b32 v93, v115, v85
    v_fmamk_f32 v112, v110, 0x41800000, v111
    v_cos_f32 v113, v112
    v_sin_f32 v114, v112
    s_nop 0
    v_cvt_pk_bf16_f32 v70, v113, v114
    v_cvt_pk_bf16_f32 v86, -v114, v113
    v_xor_b32 v78, v115, v70
    v_xor_b32 v94, v115, v86
    v_fmamk_f32 v112, v110, 0x41880000, v111
    v_cos_f32 v113, v112
    v_sin_f32 v114, v112
    s_nop 0
    v_cvt_pk_bf16_f32 v71, v113, v114
    v_cvt_pk_bf16_f32 v87, -v114, v113
    v_xor_b32 v79, v115, v71
    v_xor_b32 v95, v115, v87
    v_fmamk_f32 v112, v110, 0x41900000, v111
    v_cos_f32 v113, v112
    v_sin_f32 v114, v112
    s_nop 0
    v_cvt_pk_bf16_f32 v72, v113, v114
    v_cvt_pk_bf16_f32 v88, -v114, v113
    v_xor_b32 v80, v115, v72
    v_xor_b32 v96, v115, v88
    v_fmamk_f32 v112, v110, 0x41980000, v111
    v_cos_f32 v113, v112
    v_sin_f32 v114, v112
    s_nop 0
    v_cvt_pk_bf16_f32 v73, v113, v114
    v_cvt_pk_bf16_f32 v89, -v114, v113
    v_xor_b32 v81, v115, v73
    v_xor_b32 v97, v115, v89
    s_waitcnt lgkmcnt(0)
    s_mul_i32 s54, s54, 0x9e3779b1
    s_add_u32 s54, s54, 0x7f4a7c15
    s_or_b32 s54, s54, 1
    v_mov_b32 v117, s54
    s_waitcnt vmcnt(3)
    s_waitcnt lgkmcnt(0)
    s_barrier
    ds_read_b128 v[152:155], v59 offset:0
    ds_read_b128 v[156:159], v60 offset:1024
    ds_read_b128 v[160:163], v59 offset:2048
    ds_read_b128 v[164:167], v60 offset:3072
    ds_read_b128 v[168:171], v59 offset:4096
    ds_read_b128 v[172:175], v60 offset:5120
    ds_read_b128 v[176:179], v59 offset:6144
    ds_read_b128 v[180:183], v60 offset:7168
    v_add_u32 v61, 4096, v64
    s_waitcnt lgkmcnt(7)
    v_mfma_f32_16x16x32_bf16 v[184:187], v[152:155], v[66:69], 0
    s_waitcnt lgkmcnt(6)
    v_mfma_f32_16x16x32_bf16 v[188:191], v[152:155], v[82:85], 0
    s_waitcnt lgkmcnt(5)
    v_mfma_f32_16x16x32_bf16 v[184:187], v[156:159], v[70:73], v[184:187]
    s_waitcnt lgkmcnt(4)
    v_mfma_f32_16x16x32_bf16 v[188:191], v[156:159], v[86:89], v[188:191]
    s_waitcnt lgkmcnt(3)
    ds_read_u16 v120, v118 offset:0
    ds_read_u16_d16_hi v128, v118 offset:4096
    ds_read_u16 v121, v118 offset:1024
    ds_read_u16_d16_hi v129, v118 offset:5120
    ds_read_u16 v122, v118 offset:2048
    ds_read_u16_d16_hi v130, v118 offset:6144
    ds_read_u16 v123, v118 offset:3072
    ds_read_u16_d16_hi v131, v118 offset:7168
    ds_read_u16 v124, v118 offset:8192
    ds_read_u16_d16_hi v132, v118 offset:12288
    ds_read_u16 v125, v118 offset:9216
    ds_read_u16_d16_hi v133, v118 offset:13312
    ds_read_u16 v126, v118 offset:10240
    ds_read_u16_d16_hi v134, v118 offset:14336
    ds_read_u16 v127, v118 offset:11264
    ds_read_u16_d16_hi v135, v118 offset:15360
    v_mfma_f32_16x16x32_bf16 v[192:195], v[168:171], v[66:69], 0
    v_mfma_f32_16x16x32_bf16 v[196:199], v[168:171], v[82:85], 0
    v_mfma_f32_16x16x32_bf16 v[184:187], v[160:163], v[74:77], v[184:187]
    v_mfma_f32_16x16x32_bf16 v[188:191], v[160:163], v[90:93], v[188:191]
    v_mfma_f32_16x16x32_bf16 v[184:187], v[164:167], v[78:81], v[184:187]
    v_mfma_f32_16x16x32_bf16 v[188:191], v[164:167], v[94:97], v[188:191]
    s_waitcnt lgkmcnt(15)
    v_mfma_f32_16x16x32_bf16 v[192:195], v[172:175], v[70:73], v[192:195]
    s_waitcnt lgkmcnt(15)
    s_waitcnt lgkmcnt(15)
    s_nop 3
    v_cvt_pk_bf16_f32 v48, v184, v188
    v_cvt_pk_bf16_f32 v49, v185, v189
    v_mfma_f32_16x16x32_bf16 v[196:199], v[172:175], v[86:89], v[196:199]
    v_cvt_pk_bf16_f32 v50, v186, v190
    v_cvt_pk_bf16_f32 v51, v187, v191
    v_mfma_f32_16x16x32_bf16 v[192:195], v[176:179], v[74:77], v[192:195]
    v_mfma_f32_16x16x32_bf16 v[196:199], v[176:179], v[90:93], v[196:199]
    v_mfma_f32_16x16x32_bf16 v[192:195], v[180:183], v[78:81], v[192:195]
    v_mfma_f32_16x16x32_bf16 v[196:199], v[180:183], v[94:97], v[196:199]
    s_waitcnt lgkmcnt(0)
    v_and_b32 v128, 0xffff0000, v128
    v_and_b32 v129, 0xffff0000, v129
    v_and_b32 v130, 0xffff0000, v130
    v_and_b32 v131, 0xffff0000, v131
    buffer_store_dwordx4 v[48:51], v64, s[4:7], s49 offen sc1
    s_nop 1
    v_cvt_pk_bf16_f32 v52, v192, v196
    v_cvt_pk_bf16_f32 v53, v193, v197
    v_cvt_pk_bf16_f32 v54, v194, v198
    v_cvt_pk_bf16_f32 v55, v195, v199
    v_and_b32 v132, 0xffff0000, v132
    v_and_b32 v133, 0xffff0000, v133
    v_and_b32 v134, 0xffff0000, v134
    v_and_b32 v135, 0xffff0000, v135
    v_bitop3_b32 v120, v120, v128, s36 bitop3:0x56
    v_bitop3_b32 v121, v121, v129, s36 bitop3:0x56
    v_bitop3_b32 v122, v122, v130, s36 bitop3:0x56
    v_bitop3_b32 v123, v123, v131, s36 bitop3:0x56
    buffer_store_dwordx4 v[52:55], v61, s[4:7], s49 offen sc1
    v_bitop3_b32 v124, v124, v132, s36 bitop3:0x56
    v_bitop3_b32 v125, v125, v133, s36 bitop3:0x56
    v_bitop3_b32 v126, v126, v134, s36 bitop3:0x56
    v_bitop3_b32 v127, v127, v135, s36 bitop3:0x56
    buffer_store_dwordx4 v[120:123], v47, s[4:7], s51 offen sc1
    buffer_store_dwordx4 v[124:127], v57, s[4:7], s51 offen sc1
    v_lshrrev_b32 v51, 2, v1
    v_mul_u32_u24 v51, 3584, v51
    v_and_b32 v52, 3, v1
    v_lshl_add_u32 v52, v52, 4, v51
    v_xor_b32 v53, 32, v52
    s_lshl_b32 s41, s38, 2
    s_add_u32 s41, s41, s46
    s_lshl_b32 s41, s41, 6
    s_mul_i32 s42, s46, 28672
    v_lshrrev_b32 v51, 3, v0
    v_lshlrev_b32 v51, 9, v51
    v_and_b32 v54, 7, v0
    v_lshl_add_u32 v54, v54, 4, v51
    v_add_u32 v55, 16384, v54
    v_mov_b32 v51, 2130706432
    v_cmp_gt_u32 vcc, 192, v0
    s_nop 1
    v_cndmask_b32 v55, v51, v55, vcc
    s_lshr_b32 s43, s47, 2
    s_mul_i32 s43, s43, 28672
    s_and_b32 s36, s45, 3
    s_lshl_b32 s36, s36, 7
    s_add_u32 s43, s43, s36
    s_add_u32 s43, s43, 4194304
    s_mul_i32 s48, s37, 448
    s_mul_i32 s3, s46, 28
    s_add_u32 s48, s48, s3
    s_add_u32 s48, s48, s38
    s_lshl_b32 s48, s48, 10
    s_add_u32 s48, s48, 8388608
    s_cmp_lt_u32 s45, 28
    s_cselect_b32 s48, s48, 2130706432
    v_cvt_f32_u32 v51, v62
    v_mul_f32 v51, 0x3a000000, v51
    v_mul_f32 v56, v51, v116
    v_fmamk_f32 v59, v51, 0x00000000, v56
    v_cos_f32 v128, v59
    v_sin_f32 v150, v59
    v_fmamk_f32 v59, v51, 0x3f800000, v56
    v_cos_f32 v129, v59
    v_sin_f32 v151, v59
    v_fmamk_f32 v59, v51, 0x40000000, v56
    v_cos_f32 v130, v59
    v_sin_f32 v152, v59
    v_fmamk_f32 v59, v51, 0x40400000, v56
    v_cos_f32 v131, v59
    v_sin_f32 v153, v59
    v_fmamk_f32 v59, v51, 0x41800000, v56
    v_cos_f32 v132, v59
    v_sin_f32 v154, v59
    v_fmamk_f32 v59, v51, 0x41880000, v56
    v_cos_f32 v133, v59
    v_sin_f32 v155, v59
    v_fmamk_f32 v59, v51, 0x41900000, v56
    v_cos_f32 v134, v59
    v_sin_f32 v156, v59
    v_fmamk_f32 v59, v51, 0x41980000, v56
    v_cos_f32 v135, v59
    v_sin_f32 v157, v59
    v_cvt_f32_u32 v51, v44
    v_mul_f32 v51, 0x3d000000, v51
    v_mul_f32 v56, v51, v116
    v_fmamk_f32 v59, v51, 0x00000000, v56
    v_cos_f32 v60, v59
    v_sin_f32 v61, v59
    s_nop 0
    v_cvt_pk_bf16_f32 v158, v60, v61
    v_cvt_pk_bf16_f32 v174, -v61, v60
    v_xor_b32 v162, v115, v158
    v_mov_b32 v166, v158
    v_mov_b32 v170, v162
    v_xor_b32 v178, v115, v174
    v_mov_b32 v182, v174
    v_mov_b32 v186, v178
    v_fmamk_f32 v59, v51, 0x3f800000, v56
    v_cos_f32 v60, v59
    v_sin_f32 v61, v59
    s_nop 0
    v_cvt_pk_bf16_f32 v159, v60, v61
    v_cvt_pk_bf16_f32 v175, -v61, v60
    v_xor_b32 v163, v115, v159
    v_xor_b32 v167, 0x80008000, v159
    v_xor_b32 v171, 0x80008000, v163
    v_xor_b32 v179, v115, v175
    v_xor_b32 v183, 0x80008000, v175
    v_xor_b32 v187, 0x80008000, v179
    v_fmamk_f32 v59, v51, 0x40000000, v56
    v_cos_f32 v60, v59
    v_sin_f32 v61, v59
    s_nop 0
    v_cvt_pk_bf16_f32 v160, v60, v61
    v_cvt_pk_bf16_f32 v176, -v61, v60
    v_xor_b32 v164, v115, v160
    v_mov_b32 v168, v160
    v_mov_b32 v172, v164
    v_xor_b32 v180, v115, v176
    v_mov_b32 v184, v176
    v_mov_b32 v188, v180
    v_fmamk_f32 v59, v51, 0x40400000, v56
    v_cos_f32 v60, v59
    v_sin_f32 v61, v59
    s_nop 0
    v_cvt_pk_bf16_f32 v161, v60, v61
    v_cvt_pk_bf16_f32 v177, -v61, v60
    v_xor_b32 v165, v115, v161
    v_xor_b32 v169, 0x80008000, v161
    v_xor_b32 v173, 0x80008000, v165
    v_xor_b32 v181, v115, v177
    v_xor_b32 v185, 0x80008000, v177
    v_xor_b32 v189, 0x80008000, v181
    v_lshrrev_b32 v118, 2, v1
    v_mul_u32_u24 v118, 8448, v118
    v_and_b32 v49, 3, v1
    v_lshl_add_u32 v118, v49, 4, v118
    s_lshl_b32 s36, s46, 2
    s_lshr_b32 s3, s47, 6
    s_add_u32 s36, s36, s3
    s_mul_i32 s36, s36, 135168
    s_and_b32 s3, s47, 63
    s_lshl_b32 s3, s3, 6
    s_add_u32 s36, s36, s3
    s_add_u32 s36, s36, 18874368
    v_lshrrev_b32 v49, 1, v45
    v_lshl_add_u32 v49, v49, 5, v44
    v_mul_u32_u24 v49, 8448, v49
    v_and_b32 v51, 1, v45
    v_lshl_add_u32 v51, v51, 4, v49
    v_add_u32 v56, 135168, v51
    s_lshr_b32 s52, s47, 2
    s_lshl_b32 s52, s52, 6
    s_and_b32 s3, s47, 2
    s_lshl_b32 s3, s3, 11
    s_add_u32 s52, s52, s3
    s_and_b32 s3, s47, 1
    s_lshl_b32 s3, s3, 5
    s_add_u32 s52, s52, s3
    s_mul_i32 s3, s46, 540672
    s_add_u32 s52, s52, s3
    s_lshl_b32 s53, s46, 10
    s_add_u32 s53, s53, 122880
    v_add_u32 v59, 122880, v2
    v_lshrrev_b32 v49, 2, v44
    v_lshlrev_b32 v49, 8, v49
    v_lshl_add_u32 v49, v45, 6, v49
    v_and_b32 v60, 3, v1
    v_lshl_add_u32 v49, v60, 2, v49
    s_lshl_b32 s3, s46, 10
    s_add_u32 s3, s3, 131072
    v_add_u32 v60, s3, v49
    v_lshrrev_b32 v49, 1, v45
    v_lshlrev_b32 v49, 10, v49
    v_lshl_add_u32 v49, v44, 5, v49
    v_and_b32 v61, 1, v45
    v_lshl_add_u32 v49, v61, 4, v49
    s_lshl_b32 s3, s46, 11
    v_add_u32 v61, s3, v49
    s_lshl_b32 s55, s44, 15
    s_add_u32 s55, s55, 16252928
    v_lshlrev_b32 v63, 7, v0
    s_waitcnt vmcnt(0)
    s_barrier
    s_cmp_lg_u32 s46, 0
    s_cbranch_scc1 L_noarr_1
    s_lshl_b32 s3, s47, 7
    s_add_u32 s3, s3, 16252928
    v_lshlrev_b32 v64, 15, v0
    s_mov_b64 exec, 255
    buffer_store_dword v117, v64, s[4:7], s3 offen sc1
    s_mov_b64 exec, -1
L_noarr_1:
    s_add_u32 m0, s42, 0
    s_nop 0
    buffer_load_dwordx4 v52, s[20:23], s41 offen lds
    s_add_u32 m0, s42, 1024
    s_nop 0
    buffer_load_dwordx4 v53, s[24:27], s41 offen lds
    s_add_u32 m0, s42, 2048
    s_add_u32 s41, s41, 57344
    buffer_load_dwordx4 v52, s[20:23], s41 offen lds
    s_add_u32 m0, s42, 3072
    s_nop 0
    buffer_load_dwordx4 v53, s[24:27], s41 offen lds
    s_add_u32 m0, s42, 4096
    s_add_u32 s41, s41, 57344
    buffer_load_dwordx4 v52, s[20:23], s41 offen lds
    s_add_u32 m0, s42, 5120
    s_nop 0
    buffer_load_dwordx4 v53, s[24:27], s41 offen lds
    s_add_u32 m0, s42, 6144
    s_add_u32 s41, s41, 57344
    buffer_load_dwordx4 v52, s[20:23], s41 offen lds
    s_add_u32 m0, s42, 7168
    s_nop 0
    buffer_load_dwordx4 v53, s[24:27], s41 offen lds
    s_add_u32 m0, s42, 8192
    s_add_u32 s41, s41, 57344
    buffer_load_dwordx4 v52, s[20:23], s41 offen lds
    s_add_u32 m0, s42, 9216
    s_nop 0
    buffer_load_dwordx4 v53, s[24:27], s41 offen lds
    s_add_u32 m0, s42, 10240
    s_add_u32 s41, s41, 57344
    buffer_load_dwordx4 v52, s[20:23], s41 offen lds
    s_add_u32 m0, s42, 11264
    s_nop 0
    buffer_load_dwordx4 v53, s[24:27], s41 offen lds
    s_add_u32 m0, s42, 12288
    s_add_u32 s41, s41, 57344
    buffer_load_dwordx4 v52, s[20:23], s41 offen lds
    s_add_u32 m0, s42, 13312
    s_nop 0
    buffer_load_dwordx4 v53, s[24:27], s41 offen lds
    s_add_u32 m0, s42, 14336
    s_add_u32 s41, s41, 57344
    buffer_load_dwordx4 v52, s[20:23], s41 offen lds
    s_add_u32 m0, s42, 15360
    s_nop 0
    buffer_load_dwordx4 v53, s[24:27], s41 offen lds
    s_add_u32 m0, s42, 16384
    s_add_u32 s41, s41, 57344
    buffer_load_dwordx4 v52, s[20:23], s41 offen lds
    s_add_u32 m0, s42, 17408
    s_nop 0
    buffer_load_dwordx4 v53, s[24:27], s41 offen lds
    buffer_load_dword v48, v63, s[4:7], s55 offen sc1
    s_mov_b32 s13, 262144
    s_waitcnt vmcnt(0)
    v_cmp_ne_u32 vcc, s54, v48
    s_nop 0
    s_cbranch_vccnz L_poll_2
L_pollok_3:
    s_mov_b32 m0, s53
    s_nop 0
    buffer_load_dwordx4 v51, s[4:7], s52 offen sc1 lds
    s_add_u32 m0, s53, 4096
    s_add_u32 s3, s36, 4096
    buffer_load_dwordx4 v56, s[4:7], s52 offen sc1 lds
    buffer_load_dwordx4 v[120:123], v118, s[4:7], s36 offen sc1
    buffer_load_dwordx4 v[124:127], v118, s[4:7], s3 offen sc1
    s_waitcnt vmcnt(2)
    s_barrier
    ds_read_b128 v[192:195], v59 offset:0
    ds_read_b128 v[196:199], v59 offset:1024
    ds_read_b128 v[200:203], v59 offset:2048
    ds_read_b128 v[204:207], v59 offset:3072
    ds_read_b128 v[208:211], v59 offset:4096
    ds_read_b128 v[212:215], v59 offset:5120
    ds_read_b128 v[216:219], v59 offset:6144
    ds_read_b128 v[220:223], v59 offset:7168
    s_waitcnt lgkmcnt(7)
    v_mfma_f32_16x16x32_bf16 v[224:227], v[192:195], v[66:69], 0
    v_mfma_f32_16x16x32_bf16 v[228:231], v[192:195], v[82:85], 0
    s_waitcnt lgkmcnt(6)
    v_mfma_f32_16x16x32_bf16 v[224:227], v[196:199], v[70:73], v[224:227]
    v_mfma_f32_16x16x32_bf16 v[228:231], v[196:199], v[86:89], v[228:231]
    s_waitcnt lgkmcnt(5)
    v_mfma_f32_16x16x32_bf16 v[224:227], v[200:203], v[74:77], v[224:227]
    v_mfma_f32_16x16x32_bf16 v[228:231], v[200:203], v[90:93], v[228:231]
    s_waitcnt lgkmcnt(4)
    v_mfma_f32_16x16x32_bf16 v[224:227], v[204:207], v[78:81], v[224:227]
    v_mfma_f32_16x16x32_bf16 v[228:231], v[204:207], v[94:97], v[228:231]
    s_waitcnt lgkmcnt(3)
    v_mfma_f32_16x16x32_bf16 v[232:235], v[208:211], v[66:69], 0
    v_mfma_f32_16x16x32_bf16 v[236:239], v[208:211], v[82:85], 0
    s_waitcnt lgkmcnt(2)
    v_mfma_f32_16x16x32_bf16 v[232:235], v[212:215], v[70:73], v[232:235]
    v_mfma_f32_16x16x32_bf16 v[236:239], v[212:215], v[86:89], v[236:239]
    s_waitcnt lgkmcnt(1)
    v_mfma_f32_16x16x32_bf16 v[232:235], v[216:219], v[74:77], v[232:235]
    v_mfma_f32_16x16x32_bf16 v[236:239], v[216:219], v[90:93], v[236:239]
    s_waitcnt lgkmcnt(0)
    v_mfma_f32_16x16x32_bf16 v[232:235], v[220:223], v[78:81], v[232:235]
    v_mfma_f32_16x16x32_bf16 v[236:239], v[220:223], v[94:97], v[236:239]
    v_pk_mul_f32 v[110:111], v[228:229], v[150:151]
    v_pk_mul_f32 v[112:113], v[224:225], v[150:151]
    v_pk_fma_f32 v[224:225], v[224:225], v[128:129], v[110:111]
    v_pk_fma_f32 v[228:229], v[228:229], v[128:129], v[112:113] neg_lo:[0,0,1] neg_hi:[0,0,1]
    s_add_u32 m0, s42, 18432
    s_add_u32 s41, s41, 57344
    buffer_load_dwordx4 v52, s[20:23], s41 offen lds
    v_cvt_pk_bf16_f32 v240, v224, v228
    v_cvt_pk_bf16_f32 v241, v225, v229
    v_pk_mul_f32 v[114:115], v[230:231], v[152:153]
    v_pk_mul_f32 v[190:191], v[226:227], v[152:153]
    v_pk_fma_f32 v[226:227], v[226:227], v[130:131], v[114:115]
    v_pk_fma_f32 v[230:231], v[230:231], v[130:131], v[190:191] neg_lo:[0,0,1] neg_hi:[0,0,1]
    s_add_u32 m0, s42, 19456
    s_nop 0
    buffer_load_dwordx4 v53, s[24:27], s41 offen lds
    v_cvt_pk_bf16_f32 v242, v226, v230
    v_cvt_pk_bf16_f32 v243, v227, v231
    v_pk_mul_f32 v[248:249], v[236:237], v[154:155]
    v_pk_mul_f32 v[250:251], v[232:233], v[154:155]
    v_pk_fma_f32 v[232:233], v[232:233], v[132:133], v[248:249]
    v_pk_fma_f32 v[236:237], v[236:237], v[132:133], v[250:251] neg_lo:[0,0,1] neg_hi:[0,0,1]
    s_add_u32 m0, s42, 20480
    s_add_u32 s41, s41, 57344
    buffer_load_dwordx4 v52, s[20:23], s41 offen lds
    v_cvt_pk_bf16_f32 v244, v232, v236
    v_cvt_pk_bf16_f32 v245, v233, v237
    v_pk_mul_f32 v[252:253], v[238:239], v[156:157]
    v_pk_mul_f32 v[254:255], v[234:235], v[156:157]
    v_pk_fma_f32 v[234:235], v[234:235], v[134:135], v[252:253]
    v_pk_fma_f32 v[238:239], v[238:239], v[134:135], v[254:255] neg_lo:[0,0,1] neg_hi:[0,0,1]
    s_add_u32 m0, s42, 21504
    s_nop 0
    buffer_load_dwordx4 v53, s[24:27], s41 offen lds
    v_cvt_pk_bf16_f32 v246, v234, v238
    v_cvt_pk_bf16_f32 v247, v235, v239
    v_mfma_f32_16x16x32_bf16 v[192:195], v[158:161], v[240:243], 0
    v_mfma_f32_16x16x32_bf16 v[196:199], v[174:177], v[240:243], 0
    s_add_u32 m0, s42, 22528
    s_add_u32 s41, s41, 57344
    buffer_load_dwordx4 v52, s[20:23], s41 offen lds
    v_mfma_f32_16x16x32_bf16 v[200:203], v[166:169], v[240:243], 0
    v_mfma_f32_16x16x32_bf16 v[204:207], v[182:185], v[240:243], 0
    s_add_u32 m0, s42, 23552
    s_nop 0
    buffer_load_dwordx4 v53, s[24:27], s41 offen lds
    v_mfma_f32_16x16x32_bf16 v[192:195], v[162:165], v[244:247], v[192:195]
    v_mfma_f32_16x16x32_bf16 v[196:199], v[178:181], v[244:247], v[196:199]
    s_add_u32 m0, s42, 24576
    s_add_u32 s41, s41, 57344
    buffer_load_dwordx4 v52, s[20:23], s41 offen lds
    v_mfma_f32_16x16x32_bf16 v[200:203], v[170:173], v[244:247], v[200:203]
    v_mfma_f32_16x16x32_bf16 v[204:207], v[186:189], v[244:247], v[204:207]
    s_add_u32 m0, s42, 25600
    s_nop 0
    buffer_load_dwordx4 v53, s[24:27], s41 offen lds
    s_waitcnt vmcnt(8)
    v_lshlrev_b32 v208, 16, v120
    v_and_b32 v216, 0xffff0000, v120
    v_lshlrev_b32 v209, 16, v121
    v_and_b32 v217, 0xffff0000, v121
    v_lshlrev_b32 v210, 16, v122
    v_and_b32 v218, 0xffff0000, v122
    v_lshlrev_b32 v211, 16, v123
    v_and_b32 v219, 0xffff0000, v123
    v_lshlrev_b32 v212, 16, v124
    v_and_b32 v220, 0xffff0000, v124
    v_lshlrev_b32 v213, 16, v125
    v_and_b32 v221, 0xffff0000, v125
    v_lshlrev_b32 v214, 16, v126
    v_and_b32 v222, 0xffff0000, v126
    v_lshlrev_b32 v215, 16, v127
    v_and_b32 v223, 0xffff0000, v127
    v_pk_mul_f32 v[110:111], v[196:197], v[216:217]
    v_pk_mul_f32 v[112:113], v[192:193], v[216:217]
    v_pk_fma_f32 v[192:193], v[192:193], v[208:209], v[110:111] neg_lo:[0,0,1] neg_hi:[0,0,1]
    v_pk_fma_f32 v[196:197], v[196:197], v[208:209], v[112:113]
    s_add_u32 m0, s42, 26624
    s_add_u32 s41, s41, 57344
    buffer_load_dwordx4 v52, s[20:23], s41 offen lds
    v_cvt_pk_bf16_f32 v240, v196, v192
    v_cvt_pk_bf16_f32 v241, v197, v193
    v_pk_mul_f32 v[114:115], v[198:199], v[218:219]
    v_pk_mul_f32 v[190:191], v[194:195], v[218:219]
    v_pk_fma_f32 v[194:195], v[194:195], v[210:211], v[114:115] neg_lo:[0,0,1] neg_hi:[0,0,1]
    v_pk_fma_f32 v[198:199], v[198:199], v[210:211], v[190:191]
    s_add_u32 m0, s42, 27648
    s_nop 0
    buffer_load_dwordx4 v53, s[24:27], s41 offen lds
    s_add_u32 s41, s41, 57344
    v_cvt_pk_bf16_f32 v242, v198, v194
    v_cvt_pk_bf16_f32 v243, v199, v195
    v_pk_mul_f32 v[248:249], v[204:205], v[220:221]
    v_pk_mul_f32 v[250:251], v[200:201], v[220:221]
    v_pk_fma_f32 v[200:201], v[200:201], v[212:213], v[248:249] neg_lo:[0,0,1] neg_hi:[0,0,1]
    v_pk_fma_f32 v[204:205], v[204:205], v[212:213], v[250:251]
    v_cvt_pk_bf16_f32 v244, v204, v200
    v_cvt_pk_bf16_f32 v245, v205, v201
    v_pk_mul_f32 v[252:253], v[206:207], v[222:223]
    v_pk_mul_f32 v[254:255], v[202:203], v[222:223]
    v_pk_fma_f32 v[202:203], v[202:203], v[214:215], v[252:253] neg_lo:[0,0,1] neg_hi:[0,0,1]
    v_pk_fma_f32 v[206:207], v[206:207], v[214:215], v[254:255]
    v_cvt_pk_bf16_f32 v246, v206, v202
    v_cvt_pk_bf16_f32 v247, v207, v203
    v_mfma_f32_16x16x32_bf16 v[224:227], v[158:161], v[240:243], 0
    v_mfma_f32_16x16x32_bf16 v[228:231], v[174:177], v[240:243], 0
    v_mfma_f32_16x16x32_bf16 v[232:235], v[166:169], v[240:243], 0
    v_mfma_f32_16x16x32_bf16 v[236:239], v[182:185], v[240:243], 0
    v_mfma_f32_16x16x32_bf16 v[224:227], v[162:165], v[244:247], v[224:227]
    v_mfma_f32_16x16x32_bf16 v[228:231], v[178:181], v[244:247], v[228:231]
    v_mfma_f32_16x16x32_bf16 v[232:235], v[170:173], v[244:247], v[232:235]
    v_mfma_f32_16x16x32_bf16 v[236:239], v[186:189], v[244:247], v[236:239]
    s_nop 4
    v_pk_mul_f32 v[110:111], v[224:225], v[150:151]
    v_pk_mul_f32 v[112:113], v[228:229], v[150:151]
    v_pk_fma_f32 v[228:229], v[228:229], v[128:129], v[110:111] neg_lo:[0,0,1] neg_hi:[0,0,1]
    v_pk_fma_f32 v[224:225], v[224:225], v[128:129], v[112:113]
    v_cvt_pk_bf16_f32 v240, v224, v228
    v_cvt_pk_bf16_f32 v241, v225, v229
    v_pk_mul_f32 v[114:115], v[226:227], v[152:153]
    v_pk_mul_f32 v[190:191], v[230:231], v[152:153]
    v_pk_fma_f32 v[230:231], v[230:231], v[130:131], v[114:115] neg_lo:[0,0,1] neg_hi:[0,0,1]
    v_pk_fma_f32 v[226:227], v[226:227], v[130:131], v[190:191]
    v_cvt_pk_bf16_f32 v242, v226, v230
    v_cvt_pk_bf16_f32 v243, v227, v231
    v_pk_mul_f32 v[248:249], v[232:233], v[154:155]
    v_pk_mul_f32 v[250:251], v[236:237], v[154:155]
    v_pk_fma_f32 v[236:237], v[236:237], v[132:133], v[248:249] neg_lo:[0,0,1] neg_hi:[0,0,1]
    v_pk_fma_f32 v[232:233], v[232:233], v[132:133], v[250:251]
    v_cvt_pk_bf16_f32 v244, v232, v236
    v_cvt_pk_bf16_f32 v245, v233, v237
    v_pk_mul_f32 v[252:253], v[234:235], v[156:157]
    v_pk_mul_f32 v[254:255], v[238:239], v[156:157]
    v_pk_fma_f32 v[238:239], v[238:239], v[134:135], v[252:253] neg_lo:[0,0,1] neg_hi:[0,0,1]
    v_pk_fma_f32 v[234:235], v[234:235], v[134:135], v[254:255]
    v_cvt_pk_bf16_f32 v246, v234, v238
    v_cvt_pk_bf16_f32 v247, v235, v239
    ds_write_b32 v60, v240 offset:0
    ds_write_b32 v60, v241 offset:16
    ds_write_b32 v60, v242 offset:32
    ds_write_b32 v60, v243 offset:48
    ds_write_b32 v60, v244 offset:4096
    ds_write_b32 v60, v245 offset:4112
    ds_write_b32 v60, v246 offset:4128
    ds_write_b32 v60, v247 offset:4144
    s_waitcnt lgkmcnt(0)
    s_barrier
    ds_read_b128 v[192:195], v59 offset:8192
    ds_read_b128 v[196:199], v59 offset:9216
    ds_read_b128 v[200:203], v59 offset:10240
    ds_read_b128 v[204:207], v59 offset:11264
    ds_read_b128 v[208:211], v59 offset:12288
    ds_read_b128 v[212:215], v59 offset:13312
    ds_read_b128 v[216:219], v59 offset:14336
    ds_read_b128 v[220:223], v59 offset:15360
    s_waitcnt lgkmcnt(7)
    v_mfma_f32_16x16x32_bf16 v[224:227], v[66:69], v[192:195], 0
    v_mfma_f32_16x16x32_bf16 v[228:231], v[82:85], v[192:195], 0
    s_waitcnt lgkmcnt(6)
    v_mfma_f32_16x16x32_bf16 v[224:227], v[70:73], v[196:199], v[224:227]
    v_mfma_f32_16x16x32_bf16 v[228:231], v[86:89], v[196:199], v[228:231]
    s_waitcnt lgkmcnt(5)
    v_mfma_f32_16x16x32_bf16 v[224:227], v[74:77], v[200:203], v[224:227]
    v_mfma_f32_16x16x32_bf16 v[228:231], v[90:93], v[200:203], v[228:231]
    s_waitcnt lgkmcnt(4)
    v_mfma_f32_16x16x32_bf16 v[224:227], v[78:81], v[204:207], v[224:227]
    v_mfma_f32_16x16x32_bf16 v[228:231], v[94:97], v[204:207], v[228:231]
    s_waitcnt lgkmcnt(3)
    v_mfma_f32_16x16x32_bf16 v[232:235], v[66:69], v[208:211], 0
    v_mfma_f32_16x16x32_bf16 v[236:239], v[82:85], v[208:211], 0
    s_waitcnt lgkmcnt(2)
    v_mfma_f32_16x16x32_bf16 v[232:235], v[70:73], v[212:215], v[232:235]
    v_mfma_f32_16x16x32_bf16 v[236:239], v[86:89], v[212:215], v[236:239]
    s_waitcnt lgkmcnt(1)
    v_mfma_f32_16x16x32_bf16 v[232:235], v[74:77], v[216:219], v[232:235]
    v_mfma_f32_16x16x32_bf16 v[236:239], v[90:93], v[216:219], v[236:239]
    s_waitcnt lgkmcnt(0)
    v_mfma_f32_16x16x32_bf16 v[232:235], v[78:81], v[220:223], v[232:235]
    v_mfma_f32_16x16x32_bf16 v[236:239], v[94:97], v[220:223], v[236:239]
    v_cvt_pk_bf16_f32 v240, v228, v229
    v_cvt_pk_bf16_f32 v241, v230, v231
    v_cvt_pk_bf16_f32 v242, v224, v225
    v_cvt_pk_bf16_f32 v243, v226, v227
    buffer_store_dwordx4 v[240:243], v61, s[4:7], s50 offen offset:0 sc1
    s_nop 2
    v_cvt_pk_bf16_f32 v244, v236, v237
    v_cvt_pk_bf16_f32 v245, v238, v239
    v_cvt_pk_bf16_f32 v246, v232, v233
    v_cvt_pk_bf16_f32 v247, v234, v235
    buffer_store_dwordx4 v[244:247], v61, s[4:7], s50 offen offset:512 sc1
    v_bfe_u32 v47, v1, 3, 2
    v_lshlrev_b32 v47, 4, v47
    v_lshrrev_b32 v48, 5, v1
    v_lshl_add_u32 v47, v48, 3, v47
    v_bfe_u32 v48, v1, 2, 1
    v_lshl_add_u32 v47, v48, 2, v47
    v_bfe_u32 v48, v1, 1, 1
    v_add_u32 v47, v47, v48
    v_mul_u32_u24 v47, 8448, v47
    v_and_b32 v48, 1, v1
    v_lshl_add_u32 v50, v48, 4, v47
    v_add_u32 v51, 16896, v50
    s_mul_i32 s36, s46, 540672
    s_lshl_b32 s3, s47, 5
    s_add_u32 s36, s36, s3
    s_add_u32 s36, s36, 22020096
    s_lshl_b32 s52, s46, 10
    s_add_u32 s52, s52, 114688
    v_lshlrev_b32 v47, 7, v45
    v_bfe_u32 v48, v1, 3, 1
    v_lshl_add_u32 v47, v48, 6, v47
    v_and_b32 v48, 3, v1
    v_lshl_add_u32 v47, v48, 4, v47
    v_bfe_u32 v48, v1, 2, 1
    v_xor_b32 v48, 1, v48
    v_lshl_add_u32 v47, v48, 3, v47
    v_add_u32 v56, 114688, v47
    v_lshrrev_b32 v47, 3, v44
    v_lshlrev_b32 v47, 3, v47
    v_add_u32 v47, v47, v44
    v_mul_u32_u24 v47, 272, v47
    v_lshl_add_u32 v47, v45, 4, v47
    s_lshl_b32 s3, s46, 6
    s_add_u32 s3, s3, 122880
    v_add_u32 v57, s3, v47
    v_mul_u32_u24 v47, 272, v65
    v_lshl_add_u32 v47, v46, 3, v47
    v_add_u32 v59, 122880, v47
    v_lshrrev_b32 v47, 2, v46
    v_xor_b32 v48, v47, v65
    v_lshlrev_b32 v48, 4, v48
    v_lshl_add_u32 v47, v47, 7, v48
    v_and_b32 v48, 3, v46
    v_lshl_add_u32 v47, v48, 2, v47
    v_add_u32 v60, 140800, v47
    v_mul_u32_u24 v47, 896, v65
    v_lshl_add_u32 v47, v46, 2, v47
    v_add_u32 v61, 147968, v47
    v_lshrrev_b32 v47, 3, v0
    v_xor_b32 v48, v47, v0
    v_and_b32 v48, 7, v48
    v_lshlrev_b32 v48, 4, v48
    v_lshl_add_u32 v47, v47, 7, v48
    v_add_u32 v63, 140800, v47
    s_mul_i32 s3, s46, 1792
    s_add_u32 s3, s3, 147968
    v_add_u32 v64, s3, v2
    v_mov_b32 v47, 2130706432
    v_cmp_gt_u32 vcc, 56, v1
    s_nop 1
    v_cndmask_b32 v110, v47, v2, vcc
    s_lshl_b32 s53, s47, 2
    s_add_u32 s53, s53, s46
    s_mul_i32 s53, s53, 1792
    s_add_u32 s53, s53, 6291456
    v_bfe_u32 v111, v1, 1, 1
    v_mul_u32_u24 v111, 1056, v111
    v_bfe_u32 v114, v1, 2, 2
    v_lshl_add_u32 v111, v114, 6, v111
    v_lshrrev_b32 v114, 5, v1
    v_lshl_add_u32 v111, v114, 9, v111
    v_and_b32 v114, 1, v1
    v_lshl_add_u32 v111, v114, 4, v111
    v_bfe_u32 v114, v1, 4, 1
    v_lshl_add_u32 v111, v114, 3, v111
    v_add_u32 v112, s42, v111
    v_xor_b32 v113, 32, v112
    s_waitcnt vmcnt(2)
    ds_read_b64_tr_b16 a[0:1], v112 offset:0
    ds_read_b64_tr_b16 a[2:3], v112 offset:256
    ds_read_b64_tr_b16 a[112:113], v113 offset:0
    ds_read_b64_tr_b16 a[114:115], v113 offset:256
    ds_read_b64_tr_b16 a[4:5], v112 offset:2048
    ds_read_b64_tr_b16 a[6:7], v112 offset:2304
    ds_read_b64_tr_b16 a[116:117], v113 offset:2048
    ds_read_b64_tr_b16 a[118:119], v113 offset:2304
    ds_read_b64_tr_b16 a[8:9], v112 offset:4096
    ds_read_b64_tr_b16 a[10:11], v112 offset:4352
    ds_read_b64_tr_b16 a[120:121], v113 offset:4096
    ds_read_b64_tr_b16 a[122:123], v113 offset:4352
    ds_read_b64_tr_b16 a[12:13], v112 offset:6144
    ds_read_b64_tr_b16 a[14:15], v112 offset:6400
    ds_read_b64_tr_b16 a[124:125], v113 offset:6144
    ds_read_b64_tr_b16 a[126:127], v113 offset:6400
    ds_read_b64_tr_b16 a[16:17], v112 offset:8192
    ds_read_b64_tr_b16 a[18:19], v112 offset:8448
    ds_read_b64_tr_b16 a[128:129], v113 offset:8192
    ds_read_b64_tr_b16 a[130:131], v113 offset:8448
    ds_read_b64_tr_b16 a[20:21], v112 offset:10240
    ds_read_b64_tr_b16 a[22:23], v112 offset:10496
    ds_read_b64_tr_b16 a[132:133], v113 offset:10240
    ds_read_b64_tr_b16 a[134:135], v113 offset:10496
    ds_read_b64_tr_b16 a[24:25], v112 offset:12288
    ds_read_b64_tr_b16 a[26:27], v112 offset:12544
    ds_read_b64_tr_b16 a[136:137], v113 offset:12288
    ds_read_b64_tr_b16 a[138:139], v113 offset:12544
    ds_read_b64_tr_b16 a[28:29], v112 offset:14336
    ds_read_b64_tr_b16 a[30:31], v112 offset:14592
    ds_read_b64_tr_b16 a[140:141], v113 offset:14336
    ds_read_b64_tr_b16 a[142:143], v113 offset:14592
    ds_read_b64_tr_b16 a[32:33], v112 offset:16384
    ds_read_b64_tr_b16 a[34:35], v112 offset:16640
    ds_read_b64_tr_b16 a[144:145], v113 offset:16384
    ds_read_b64_tr_b16 a[146:147], v113 offset:16640
    ds_read_b64_tr_b16 a[36:37], v112 offset:18432
    ds_read_b64_tr_b16 a[38:39], v112 offset:18688
    ds_read_b64_tr_b16 a[148:149], v113 offset:18432
    ds_read_b64_tr_b16 a[150:151], v113 offset:18688
    ds_read_b64_tr_b16 a[40:41], v112 offset:20480
    ds_read_b64_tr_b16 a[42:43], v112 offset:20736
    ds_read_b64_tr_b16 a[152:153], v113 offset:20480
    ds_read_b64_tr_b16 a[154:155], v113 offset:20736
    ds_read_b64_tr_b16 a[44:45], v112 offset:22528
    ds_read_b64_tr_b16 a[46:47], v112 offset:22784
    ds_read_b64_tr_b16 a[156:157], v113 offset:22528
    ds_read_b64_tr_b16 a[158:159], v113 offset:22784
    ds_read_b64_tr_b16 a[48:49], v112 offset:24576
    ds_read_b64_tr_b16 a[50:51], v112 offset:24832
    ds_read_b64_tr_b16 a[160:161], v113 offset:24576
    ds_read_b64_tr_b16 a[162:163], v113 offset:24832
    ds_read_b64_tr_b16 a[52:53], v112 offset:26624
    ds_read_b64_tr_b16 a[54:55], v112 offset:26880
    ds_read_b64_tr_b16 a[164:165], v113 offset:26624
    ds_read_b64_tr_b16 a[166:167], v113 offset:26880
    s_waitcnt vmcnt(0)
    s_lshl_b32 s55, s37, 2
    s_add_u32 s55, s55, s46
    s_lshl_b32 s56, s55, 9
    s_add_u32 s56, s56, 15728640
    s_mul_i32 s55, s55, 28672
    s_add_u32 s55, s55, 4194304
    v_add_u32 v8, 57344, v2
    v_and_b32 v10, 3, v1
    v_lshlrev_b32 v10, 7, v10
    v_lshrrev_b32 v111, 3, v1
    v_mul_u32_u24 v111, 896, v111
    v_bfe_u32 v114, v1, 4, 1
    v_lshlrev_b32 v114, 2, v114
    v_xor_b32 v114, v114, v1
    v_and_b32 v114, 7, v114
    v_lshl_add_u32 v12, v114, 4, v111
    v_add_u32 v13, 7168, v12
    s_mul_i32 s57, s46, 12288
    s_add_u32 s57, s57, 114688
    s_mul_i32 s58, s46, 28672
    s_lshl_b32 s3, s40, 7
    s_add_u32 s58, s58, s3
    v_lshrrev_b32 v111, 5, v1
    v_lshlrev_b32 v111, 10, v111
    v_bfe_u32 v114, v1, 2, 2
    v_lshl_add_u32 v111, v114, 7, v111
    v_bfe_u32 v114, v1, 3, 1
    s_and_b32 s3, s46, 1
    v_xor_b32 v114, s3, v114
    v_lshl_add_u32 v111, v114, 6, v111
    v_and_b32 v114, 1, v1
    v_lshl_add_u32 v111, v114, 5, v111
    v_bfe_u32 v114, v1, 4, 1
    v_lshl_add_u32 v111, v114, 4, v111
    v_bfe_u32 v114, v1, 1, 1
    v_lshl_add_u32 v111, v114, 3, v111
    v_add_u32 v14, s57, v111
    v_xor_b32 v15, 64, v14
    s_mul_i32 s59, s39, 224
    s_mul_i32 s3, s46, 28
    s_add_u32 s59, s59, s3
    s_lshl_b32 s59, s59, 10
    s_add_u32 s59, s59, 8388608
    s_lshr_b32 s3, s46, 1
    s_mul_i32 s3, s3, 114688
    v_add_u32 v16, s3, v2
    s_sub_u32 s3, 114688, s3
    v_add_u32 v17, s3, v2
    v_min_u32 v111, 13, v1
    s_lshr_b32 s3, s39, 1
    v_lshl_add_u32 v111, v111, 4, s3
    v_mul_u32_u24 v114, 2341, v111
    v_lshrrev_b32 v114, 16, v114
    v_lshl_add_u32 v111, v114, 2, v111
    v_and_b32 v114, 7, v1
    s_lshl_b32 s3, s39, 3
    v_add_u32 v114, s3, v114
    v_cmp_gt_u32 vcc, 16, v1
    s_nop 1
    v_cndmask_b32 v111, v114, v111, vcc
    v_lshlrev_b32 v9, 7, v111
    v_lshrrev_b32 v111, 5, v1
    v_lshlrev_b32 v111, 5, v111
    v_mul_u32_u24 v19, 896, v46
    v_add_u32 v19, v19, v111
    v_and_b32 v18, 7, v1
    v_lshlrev_b32 v18, 5, v18
    v_lshrrev_b32 v114, 3, v46
    v_add_u32 v18, v18, v114
    v_mul_u32_u24 v18, 896, v18
    v_add_u32 v18, v18, v111
    s_lshl_b32 s60, s40, 1
    s_and_b32 s3, s46, 1
    s_add_u32 s60, s60, s3
    s_lshl_b32 s60, s60, 6
    s_lshl_b32 s61, s39, 1
    s_lshr_b32 s3, s46, 1
    s_add_u32 s61, s61, s3
    s_and_b32 s3, s61, 7
    s_lshl_b32 s3, s3, 2
    s_lshr_b32 s62, s61, 3
    s_lshl_b32 s62, s62, 8
    s_add_u32 s3, s3, s62
    s_mul_i32 s3, s3, 896
    s_mul_i32 s61, s61, 28672
    s_add_u32 s61, s61, s60
    s_add_u32 s61, s61, 6291456
    s_add_u32 s60, s60, s3
    v_add_u32 v20, s57, v2
    s_xor_b32 s3, s46, 1
    s_mul_i32 s3, s3, 12288
    s_add_u32 s3, s3, 114688
    v_add_u32 v21, s3, v2
    s_xor_b32 s3, s46, 2
    s_mul_i32 s3, s3, 12288
    s_add_u32 s3, s3, 118784
    v_add_u32 v22, s3, v2
    s_xor_b32 s3, s46, 3
    s_mul_i32 s3, s3, 12288
    s_add_u32 s3, s3, 122880
    v_add_u32 v23, s3, v2
    s_waitcnt lgkmcnt(0)
    s_mov_b32 m0, s52
    s_nop 0
    buffer_load_dwordx4 v50, s[4:7], s36 offen sc1 lds
    s_add_u32 m0, s52, 4096
    s_nop 0
    buffer_load_dwordx4 v51, s[4:7], s36 offen sc1 lds
    s_mov_b32 s13, 262144
    s_waitcnt vmcnt(0)
L_p3_4:
    s_barrier
    ds_read_b64_tr_b16 v[152:153], v56 offset:0
    ds_read_b64_tr_b16 v[154:155], v56 offset:512
    ds_read_b64_tr_b16 v[156:157], v56 offset:1024
    ds_read_b64_tr_b16 v[158:159], v56 offset:1536
    ds_read_b64_tr_b16 v[160:161], v56 offset:2048
    ds_read_b64_tr_b16 v[162:163], v56 offset:2560
    ds_read_b64_tr_b16 v[164:165], v56 offset:3072
    ds_read_b64_tr_b16 v[166:167], v56 offset:3584
    ds_read_b64_tr_b16 v[168:169], v56 offset:4096
    ds_read_b64_tr_b16 v[170:171], v56 offset:4608
    ds_read_b64_tr_b16 v[172:173], v56 offset:5120
    ds_read_b64_tr_b16 v[174:175], v56 offset:5632
    ds_read_b64_tr_b16 v[176:177], v56 offset:6144
    ds_read_b64_tr_b16 v[178:179], v56 offset:6656
    ds_read_b64_tr_b16 v[180:181], v56 offset:7168
    ds_read_b64_tr_b16 v[182:183], v56 offset:7680
    s_add_u32 s3, s12, 688128
    s_mov_b32 exec_hi, 0
    buffer_load_dword v3, v58, s[8:11], s3 offen
    s_mov_b64 exec, -1
    s_lshl_b32 s3, s2, 2
    s_add_u32 s3, s3, s46
    s_mul_i32 s3, s3, 1664
    v_lshlrev_b32 v111, 3, v2
    s_mov_b64 exec, 0x1fff
    buffer_load_dword v3, v111, s[28:31], s3 offen
    s_mov_b64 exec, -1
    s_waitcnt lgkmcnt(14)
    v_mfma_f32_16x16x32_bf16 v[120:123], v[66:69], v[152:155], 0
    v_mfma_f32_16x16x32_bf16 v[124:127], v[82:85], v[152:155], 0
    v_pk_max_u16 v47, v152, v153
    v_mov_b32 v49, v47
    v_pk_max_u16 v47, v154, v155
    v_pk_max_u16 v49, v49, v47
    s_waitcnt lgkmcnt(12)
    v_mfma_f32_16x16x32_bf16 v[120:123], v[70:73], v[156:159], v[120:123]
    v_mfma_f32_16x16x32_bf16 v[124:127], v[86:89], v[156:159], v[124:127]
    v_pk_max_u16 v47, v156, v157
    v_pk_max_u16 v49, v49, v47
    v_pk_max_u16 v47, v158, v159
    v_pk_max_u16 v49, v49, v47
    s_waitcnt lgkmcnt(10)
    v_mfma_f32_16x16x32_bf16 v[120:123], v[74:77], v[160:163], v[120:123]
    v_mfma_f32_16x16x32_bf16 v[124:127], v[90:93], v[160:163], v[124:127]
    v_pk_max_u16 v47, v160, v161
    v_pk_max_u16 v49, v49, v47
    v_pk_max_u16 v47, v162, v163
    v_pk_max_u16 v49, v49, v47
    s_waitcnt lgkmcnt(8)
    v_mfma_f32_16x16x32_bf16 v[120:123], v[78:81], v[164:167], v[120:123]
    v_mfma_f32_16x16x32_bf16 v[124:127], v[94:97], v[164:167], v[124:127]
    v_pk_max_u16 v47, v164, v165
    v_pk_max_u16 v49, v49, v47
    v_pk_max_u16 v47, v166, v167
    v_pk_max_u16 v49, v49, v47
    s_waitcnt lgkmcnt(6)
    v_mfma_f32_16x16x32_bf16 v[128:131], v[66:69], v[168:171], 0
    v_mfma_f32_16x16x32_bf16 v[132:135], v[82:85], v[168:171], 0
    v_pk_max_u16 v47, v168, v169
    v_pk_max_u16 v49, v49, v47
    v_pk_max_u16 v47, v170, v171
    v_pk_max_u16 v49, v49, v47
    s_waitcnt lgkmcnt(4)
    v_mfma_f32_16x16x32_bf16 v[128:131], v[70:73], v[172:175], v[128:131]
    v_mfma_f32_16x16x32_bf16 v[132:135], v[86:89], v[172:175], v[132:135]
    v_pk_max_u16 v47, v172, v173
    v_pk_max_u16 v49, v49, v47
    v_pk_max_u16 v47, v174, v175
    v_pk_max_u16 v49, v49, v47
    s_waitcnt lgkmcnt(2)
    v_mfma_f32_16x16x32_bf16 v[128:131], v[74:77], v[176:179], v[128:131]
    v_mfma_f32_16x16x32_bf16 v[132:135], v[90:93], v[176:179], v[132:135]
    v_pk_max_u16 v47, v176, v177
    v_pk_max_u16 v49, v49, v47
    v_pk_max_u16 v47, v178, v179
    v_pk_max_u16 v49, v49, v47
    s_waitcnt lgkmcnt(0)
    v_mfma_f32_16x16x32_bf16 v[128:131], v[78:81], v[180:183], v[128:131]
    v_mfma_f32_16x16x32_bf16 v[132:135], v[94:97], v[180:183], v[132:135]
    v_pk_max_u16 v47, v180, v181
    v_pk_max_u16 v49, v49, v47
    v_pk_max_u16 v47, v182, v183
    v_pk_max_u16 v49, v49, v47
    v_lshlrev_b32 v47, 16, v49
    v_max_u32 v49, v49, v47
    v_cmp_le_u32 vcc, 0xffff0000, v49
    s_nop 0
    s_cbranch_vccnz L_p3fail_5
L_p3ok_6:
    s_or_b32 s3, s2, s46
    s_cmp_lg_u32 s3, 0
    s_cbranch_scc1 L_noepo_7
    v_mov_b32 v48, 16121856
    s_mov_b64 exec, 1
    buffer_store_dword v117, v48, s[4:7], 0 offen sc1
    s_mov_b64 exec, -1
L_noepo_7:
    ds_write_b128 v57, v[124:127] offset:0
    ds_write_b128 v57, v[120:123] offset:2176
    ds_write_b128 v57, v[132:135] offset:8704
    ds_write_b128 v57, v[128:131] offset:10880
    s_waitcnt lgkmcnt(0)
    s_barrier
    s_add_u32 s3, s48, 0
    buffer_store_dwordx4 v[4:7], v2, s[4:7], s3 offen sc1
    s_add_u32 s3, s48, 114688
    buffer_store_dwordx4 v[4:7], v2, s[4:7], s3 offen sc1
    s_add_u32 s3, s48, 229376
    buffer_store_dwordx4 v[4:7], v2, s[4:7], s3 offen sc1
    s_add_u32 s3, s48, 344064
    buffer_store_dwordx4 v[4:7], v2, s[4:7], s3 offen sc1
    ds_read_b64 v[68:69], v59 offset:4352
    ds_read_b64 v[74:75], v59 offset:6528
    ds_read_b64 v[70:71], v59 offset:8704
    ds_read_b64 v[76:77], v59 offset:10880
    ds_read_b64 v[72:73], v59 offset:13056
    ds_read_b64 v[78:79], v59 offset:15232
    ds_read_b64 v[66:67], v59 offset:0
    s_waitcnt lgkmcnt(5)
    v_pk_mul_f32 v[92:93], v[74:75], v[104:105]
    v_pk_mul_f32 v[94:95], v[68:69], v[104:105]
    v_pk_fma_f32 v[68:69], v[68:69], v[98:99], v[92:93] neg_lo:[0,0,1] neg_hi:[0,0,1]
    v_pk_fma_f32 v[74:75], v[74:75], v[98:99], v[94:95]
    s_waitcnt lgkmcnt(3)
    v_pk_mul_f32 v[92:93], v[76:77], v[106:107]
    v_pk_mul_f32 v[94:95], v[70:71], v[106:107]
    v_pk_fma_f32 v[70:71], v[70:71], v[100:101], v[92:93] neg_lo:[0,0,1] neg_hi:[0,0,1]
    v_pk_fma_f32 v[76:77], v[76:77], v[100:101], v[94:95]
    s_waitcnt lgkmcnt(1)
    v_pk_mul_f32 v[92:93], v[78:79], v[108:109]
    v_pk_mul_f32 v[94:95], v[72:73], v[108:109]
    v_pk_fma_f32 v[72:73], v[72:73], v[102:103], v[92:93] neg_lo:[0,0,1] neg_hi:[0,0,1]
    v_pk_fma_f32 v[78:79], v[78:79], v[102:103], v[94:95]
    s_waitcnt lgkmcnt(0)
    v_pk_fma_f32 v[80:81], v[68:69], s[14:15], v[66:67] op_sel_hi:[1,0,1]
    v_pk_mul_f32 v[86:87], v[74:75], s[14:15] op_sel:[0,1]
    v_pk_fma_f32 v[80:81], v[70:71], s[16:17], v[80:81] op_sel_hi:[1,0,1]
    v_pk_fma_f32 v[86:87], v[76:77], s[16:17], v[86:87] op_sel:[0,1,0]
    v_pk_fma_f32 v[80:81], v[72:73], s[18:19], v[80:81] op_sel_hi:[1,0,1]
    v_pk_fma_f32 v[86:87], v[78:79], s[18:19], v[86:87] op_sel:[0,1,0]
    v_pk_fma_f32 v[82:83], v[68:69], s[16:17], v[66:67] op_sel_hi:[1,0,1]
    v_pk_mul_f32 v[88:89], v[74:75], s[16:17] op_sel:[0,1]
    v_pk_fma_f32 v[82:83], v[70:71], s[18:19], v[82:83] op_sel_hi:[1,0,1]
    v_pk_fma_f32 v[88:89], v[76:77], s[18:19], v[88:89] op_sel:[0,1,0] neg_lo:[0,1,0] neg_hi:[0,1,0]
    v_pk_fma_f32 v[82:83], v[72:73], s[14:15], v[82:83] op_sel_hi:[1,0,1]
    v_pk_fma_f32 v[88:89], v[78:79], s[14:15], v[88:89] op_sel:[0,1,0] neg_lo:[0,1,0] neg_hi:[0,1,0]
    v_pk_fma_f32 v[84:85], v[68:69], s[18:19], v[66:67] op_sel_hi:[1,0,1]
    v_pk_mul_f32 v[90:91], v[74:75], s[18:19] op_sel:[0,1]
    v_pk_fma_f32 v[84:85], v[70:71], s[14:15], v[84:85] op_sel_hi:[1,0,1]
    v_pk_fma_f32 v[90:91], v[76:77], s[14:15], v[90:91] op_sel:[0,1,0] neg_lo:[0,1,0] neg_hi:[0,1,0]
    v_pk_fma_f32 v[84:85], v[72:73], s[16:17], v[84:85] op_sel_hi:[1,0,1]
    v_pk_fma_f32 v[90:91], v[78:79], s[16:17], v[90:91] op_sel:[0,1,0]
    v_pk_add_f32 v[92:93], v[66:67], v[68:69]
    v_pk_add_f32 v[94:95], v[70:71], v[72:73]
    v_pk_add_f32 v[92:93], v[92:93], v[136:137]
    v_pk_add_f32 v[118:119], v[92:93], v[94:95]
    v_pk_add_f32 v[92:93], v[80:81], v[138:139]
    v_pk_add_f32 v[94:95], v[80:81], v[148:149]
    v_pk_add_f32 v[120:121], v[92:93], v[86:87] neg_lo:[0,1] neg_hi:[0,1]
    v_pk_add_f32 v[130:131], v[94:95], v[86:87]
    v_pk_add_f32 v[92:93], v[82:83], v[140:141]
    v_pk_add_f32 v[94:95], v[82:83], v[146:147]
    v_pk_add_f32 v[122:123], v[92:93], v[88:89] neg_lo:[0,1] neg_hi:[0,1]
    v_pk_add_f32 v[128:129], v[94:95], v[88:89]
    v_pk_add_f32 v[92:93], v[84:85], v[142:143]
    v_pk_add_f32 v[94:95], v[84:85], v[144:145]
    v_pk_add_f32 v[124:125], v[92:93], v[90:91] neg_lo:[0,1] neg_hi:[0,1]
    v_pk_add_f32 v[126:127], v[94:95], v[90:91]
    v_pk_mul_f32 v[80:81], v[118:119], v[118:119]
    v_pk_add_f32 v[82:83], v[118:119], v[120:121]
    v_pk_fma_f32 v[80:81], v[120:121], v[120:121], v[80:81]
    v_pk_fma_f32 v[80:81], v[122:123], v[122:123], v[80:81]
    v_pk_add_f32 v[82:83], v[82:83], v[122:123]
    v_pk_fma_f32 v[80:81], v[124:125], v[124:125], v[80:81]
    v_pk_add_f32 v[82:83], v[82:83], v[124:125]
    v_pk_fma_f32 v[80:81], v[126:127], v[126:127], v[80:81]
    v_pk_add_f32 v[82:83], v[82:83], v[126:127]
    v_pk_fma_f32 v[80:81], v[128:129], v[128:129], v[80:81]
    v_pk_add_f32 v[82:83], v[82:83], v[128:129]
    v_pk_fma_f32 v[80:81], v[130:131], v[130:131], v[80:81]
    v_pk_add_f32 v[82:83], v[82:83], v[130:131]
    v_add_f32 v86, v82, v83
    v_add_f32 v87, v80, v81
    v_cvt_pk_bf16_f32 v136, v118, v119
    ds_write_b32 v61, v136 offset:0
    v_cvt_pk_bf16_f32 v137, v120, v121
    ds_write_b32 v61, v137 offset:128
    v_cvt_pk_bf16_f32 v138, v122, v123
    ds_write_b32 v61, v138 offset:256
    v_cvt_pk_bf16_f32 v139, v124, v125
    ds_write_b32 v61, v139 offset:384
    v_cvt_pk_bf16_f32 v140, v126, v127
    ds_write_b32 v61, v140 offset:512
    v_cvt_pk_bf16_f32 v141, v128, v129
    ds_write_b32 v61, v141 offset:640
    v_cvt_pk_bf16_f32 v142, v130, v131
    ds_write_b32 v61, v142 offset:768
    v_add_f32_dpp v86, v86, v86 row_ror:8 row_mask:0xf bank_mask:0xf
    v_add_f32_dpp v87, v87, v87 row_ror:8 row_mask:0xf bank_mask:0xf
    s_nop 0
    v_add_f32_dpp v86, v86, v86 row_ror:4 row_mask:0xf bank_mask:0xf
    v_add_f32_dpp v87, v87, v87 row_ror:4 row_mask:0xf bank_mask:0xf
    s_nop 0
    v_add_f32_dpp v86, v86, v86 row_ror:2 row_mask:0xf bank_mask:0xf
    v_add_f32_dpp v87, v87, v87 row_ror:2 row_mask:0xf bank_mask:0xf
    s_nop 0
    v_add_f32_dpp v86, v86, v86 row_ror:1 row_mask:0xf bank_mask:0xf
    v_add_f32_dpp v87, v87, v87 row_ror:1 row_mask:0xf bank_mask:0xf
    v_mov_b32 v47, v86
    v_mov_b32 v48, v87
    s_nop 0
    v_permlane16_swap_b32 v86, v47
    v_permlane16_swap_b32 v87, v48
    v_add_f32 v86, v86, v47
    v_add_f32 v87, v87, v48
    v_mul_f32 v86, 0x3b124925, v86
    v_mul_f32 v87, 0x3b124925, v87
    v_fma_f32 v87, -v86, v86, v87
    v_max_f32 v87, 0, v87
    v_cvt_pk_bf16_f32 v87, 0, v87
    v_add_f32 v87, 0x3727c5ac, v87
    v_cvt_pk_bf16_f32 v87, 0, v87
    v_sqrt_f32 v87, v87
    v_cvt_pk_bf16_f32 v88, 0, v86
    v_cvt_pk_bf16_f32 v87, 0, v87
    v_rcp_f32 v92, v87
    s_nop 0
    v_mul_f32 v93, -v88, v92
    v_pk_fma_f32 v[118:119], v[118:119], v[92:93], v[92:93] op_sel:[0,0,1] op_sel_hi:[1,0,1]
    v_cvt_pk_bf16_f32 v143, v118, v119
    ds_write_b32 v60, v143 offset:0
    v_pk_fma_f32 v[120:121], v[120:121], v[92:93], v[92:93] op_sel:[0,0,1] op_sel_hi:[1,0,1]
    v_cvt_pk_bf16_f32 v144, v120, v121
    ds_write_b32 v60, v144 offset:1024
    v_pk_fma_f32 v[122:123], v[122:123], v[92:93], v[92:93] op_sel:[0,0,1] op_sel_hi:[1,0,1]
    v_cvt_pk_bf16_f32 v145, v122, v123
    ds_write_b32 v60, v145 offset:2048
    v_pk_fma_f32 v[124:125], v[124:125], v[92:93], v[92:93] op_sel:[0,0,1] op_sel_hi:[1,0,1]
    v_cvt_pk_bf16_f32 v146, v124, v125
    ds_write_b32 v60, v146 offset:3072
    v_pk_fma_f32 v[126:127], v[126:127], v[92:93], v[92:93] op_sel:[0,0,1] op_sel_hi:[1,0,1]
    v_cvt_pk_bf16_f32 v147, v126, v127
    ds_write_b32 v60, v147 offset:4096
    v_pk_fma_f32 v[128:129], v[128:129], v[92:93], v[92:93] op_sel:[0,0,1] op_sel_hi:[1,0,1]
    v_cvt_pk_bf16_f32 v148, v128, v129
    ds_write_b32 v60, v148 offset:5120
    v_pk_fma_f32 v[130:131], v[130:131], v[92:93], v[92:93] op_sel:[0,0,1] op_sel_hi:[1,0,1]
    v_cvt_pk_bf16_f32 v149, v130, v131
    ds_write_b32 v60, v149 offset:6144
    s_waitcnt lgkmcnt(0)
    s_barrier
    ds_read_b128 v[152:155], v63
    ds_read_b128 v[156:159], v63 offset:4096
    ds_read_b128 v[160:163], v64
    ds_read_b128 v[164:167], v64 offset:896
    s_waitcnt lgkmcnt(3)
    buffer_store_dwordx4 v[152:155], v54, s[4:7], s43 offen sc1
    s_waitcnt lgkmcnt(2)
    buffer_store_dwordx4 v[156:159], v55, s[4:7], s43 offen sc1
    s_waitcnt lgkmcnt(1)
    buffer_store_dwordx4 v[160:163], v110, s[4:7], s53 offen sc1
    s_waitcnt lgkmcnt(0)
    buffer_store_dwordx4 v[164:167], v110, s[4:7], s53 offen offset:896 sc1
    s_add_u32 m0, s42, 0
    s_nop 0
    buffer_load_dwordx4 v52, s[20:23], s41 offen lds
    s_add_u32 m0, s42, 1024
    s_nop 0
    buffer_load_dwordx4 v53, s[24:27], s41 offen lds
    s_add_u32 m0, s42, 2048
    s_add_u32 s41, s41, 57344
    buffer_load_dwordx4 v52, s[20:23], s41 offen lds
    s_add_u32 m0, s42, 3072
    s_nop 0
    buffer_load_dwordx4 v53, s[24:27], s41 offen lds
    s_add_u32 m0, s42, 4096
    s_add_u32 s41, s41, 57344
    buffer_load_dwordx4 v52, s[20:23], s41 offen lds
    s_add_u32 m0, s42, 5120
    s_nop 0
    buffer_load_dwordx4 v53, s[24:27], s41 offen lds
    s_add_u32 m0, s42, 6144
    s_add_u32 s41, s41, 57344
    buffer_load_dwordx4 v52, s[20:23], s41 offen lds
    s_add_u32 m0, s42, 7168
    s_nop 0
    buffer_load_dwordx4 v53, s[24:27], s41 offen lds
    s_waitcnt vmcnt(8)
    s_barrier
    s_cmp_lg_u32 s46, 0
    s_cbranch_scc1 L_noarr_8
    s_lshl_b32 s3, s47, 7
    s_add_u32 s3, s3, 15728640
    v_lshlrev_b32 v44, 15, v0
    s_mov_b64 exec, 1
    buffer_store_dword v117, v44, s[4:7], s3 offen sc1
    s_mov_b64 exec, -1
L_noarr_8:
    s_cmp_ge_u32 s45, 28
    s_cbranch_scc1 L_fin
    s_add_u32 m0, s42, 8192
    s_add_u32 s41, s41, 57344
    buffer_load_dwordx4 v52, s[20:23], s41 offen lds
    s_add_u32 m0, s42, 9216
    s_nop 0
    buffer_load_dwordx4 v53, s[24:27], s41 offen lds
    s_add_u32 m0, s42, 10240
    s_add_u32 s41, s41, 57344
    buffer_load_dwordx4 v52, s[20:23], s41 offen lds
    s_add_u32 m0, s42, 11264
    s_nop 0
    buffer_load_dwordx4 v53, s[24:27], s41 offen lds
    s_add_u32 m0, s42, 12288
    s_add_u32 s41, s41, 57344
    buffer_load_dwordx4 v52, s[20:23], s41 offen lds
    s_add_u32 m0, s42, 13312
    s_nop 0
    buffer_load_dwordx4 v53, s[24:27], s41 offen lds
    s_add_u32 m0, s42, 14336
    s_add_u32 s41, s41, 57344
    buffer_load_dwordx4 v52, s[20:23], s41 offen lds
    s_add_u32 m0, s42, 15360
    s_nop 0
    buffer_load_dwordx4 v53, s[24:27], s41 offen lds
    s_add_u32 m0, s42, 16384
    s_add_u32 s41, s41, 57344
    buffer_load_dwordx4 v52, s[20:23], s41 offen lds
    s_add_u32 m0, s42, 17408
    s_nop 0
    buffer_load_dwordx4 v53, s[24:27], s41 offen lds
    s_add_u32 m0, s42, 18432
    s_add_u32 s41, s41, 57344
    buffer_load_dwordx4 v52, s[20:23], s41 offen lds
    s_add_u32 m0, s42, 19456
    s_nop 0
    buffer_load_dwordx4 v53, s[24:27], s41 offen lds
    s_add_u32 m0, s42, 20480
    s_add_u32 s41, s41, 57344
    buffer_load_dwordx4 v52, s[20:23], s41 offen lds
    s_add_u32 m0, s42, 21504
    s_nop 0
    buffer_load_dwordx4 v53, s[24:27], s41 offen lds
    s_add_u32 m0, s42, 22528
    s_add_u32 s41, s41, 57344
    buffer_load_dwordx4 v52, s[20:23], s41 offen lds
    s_add_u32 m0, s42, 23552
    s_nop 0
    buffer_load_dwordx4 v53, s[24:27], s41 offen lds
    s_add_u32 m0, s42, 24576
    s_add_u32 s41, s41, 57344
    buffer_load_dwordx4 v52, s[20:23], s41 offen lds
    s_add_u32 m0, s42, 25600
    s_nop 0
    buffer_load_dwordx4 v53, s[24:27], s41 offen lds
    s_add_u32 m0, s42, 26624
    s_add_u32 s41, s41, 57344
    buffer_load_dwordx4 v52, s[20:23], s41 offen lds
    s_add_u32 m0, s42, 27648
    s_nop 0
    buffer_load_dwordx4 v53, s[24:27], s41 offen lds
    s_add_u32 s41, s41, 57344
    s_add_u32 m0, s57, 0
    s_add_u32 s62, s58, 0
    buffer_load_dwordx4 v12, s[28:31], s62 offen lds
    s_add_u32 m0, s57, 1024
    s_nop 0
    buffer_load_dwordx4 v13, s[28:31], s62 offen lds
    s_add_u32 m0, s57, 2048
    s_add_u32 s62, s58, 114688
    buffer_load_dwordx4 v12, s[28:31], s62 offen lds
    s_add_u32 m0, s57, 3072
    s_nop 0
    buffer_load_dwordx4 v13, s[28:31], s62 offen lds
    s_add_u32 m0, s57, 4096
    s_add_u32 s62, s58, 229376
    buffer_load_dwordx4 v12, s[28:31], s62 offen lds
    s_add_u32 m0, s57, 5120
    s_nop 0
    buffer_load_dwordx4 v13, s[28:31], s62 offen lds
    s_add_u32 m0, s57, 6144
    s_add_u32 s62, s58, 344064
    buffer_load_dwordx4 v12, s[28:31], s62 offen lds
    s_add_u32 m0, s57, 7168
    s_nop 0
    buffer_load_dwordx4 v13, s[28:31], s62 offen lds
    s_add_u32 m0, s57, 8192
    s_add_u32 s62, s58, 458752
    buffer_load_dwordx4 v12, s[28:31], s62 offen lds
    s_add_u32 m0, s57, 9216
    s_nop 0
    buffer_load_dwordx4 v13, s[28:31], s62 offen lds
    s_add_u32 m0, s57, 10240
    s_add_u32 s62, s58, 573440
    buffer_load_dwordx4 v12, s[28:31], s62 offen lds
    s_add_u32 m0, s57, 11264
    s_nop 0
    buffer_load_dwordx4 v13, s[28:31], s62 offen lds
    buffer_load_dword v11, v10, s[4:7], s56 offen sc1
    s_waitcnt vmcnt(13)
    ds_read_b64_tr_b16 a[56:57], v112 offset:0
    ds_read_b64_tr_b16 a[58:59], v112 offset:256
    ds_read_b64_tr_b16 a[168:169], v113 offset:0
    ds_read_b64_tr_b16 a[170:171], v113 offset:256
    ds_read_b64_tr_b16 a[60:61], v112 offset:2048
    ds_read_b64_tr_b16 a[62:63], v112 offset:2304
    ds_read_b64_tr_b16 a[172:173], v113 offset:2048
    ds_read_b64_tr_b16 a[174:175], v113 offset:2304
    ds_read_b64_tr_b16 a[64:65], v112 offset:4096
    ds_read_b64_tr_b16 a[66:67], v112 offset:4352
    ds_read_b64_tr_b16 a[176:177], v113 offset:4096
    ds_read_b64_tr_b16 a[178:179], v113 offset:4352
    ds_read_b64_tr_b16 a[68:69], v112 offset:6144
    ds_read_b64_tr_b16 a[70:71], v112 offset:6400
    ds_read_b64_tr_b16 a[180:181], v113 offset:6144
    ds_read_b64_tr_b16 a[182:183], v113 offset:6400
    ds_read_b64_tr_b16 a[72:73], v112 offset:8192
    ds_read_b64_tr_b16 a[74:75], v112 offset:8448
    ds_read_b64_tr_b16 a[184:185], v113 offset:8192
    ds_read_b64_tr_b16 a[186:187], v113 offset:8448
    ds_read_b64_tr_b16 a[76:77], v112 offset:10240
    ds_read_b64_tr_b16 a[78:79], v112 offset:10496
    ds_read_b64_tr_b16 a[188:189], v113 offset:10240
    ds_read_b64_tr_b16 a[190:191], v113 offset:10496
    ds_read_b64_tr_b16 a[80:81], v112 offset:12288
    ds_read_b64_tr_b16 a[82:83], v112 offset:12544
    ds_read_b64_tr_b16 a[192:193], v113 offset:12288
    ds_read_b64_tr_b16 a[194:195], v113 offset:12544
    ds_read_b64_tr_b16 a[84:85], v112 offset:14336
    ds_read_b64_tr_b16 a[86:87], v112 offset:14592
    ds_read_b64_tr_b16 a[196:197], v113 offset:14336
    ds_read_b64_tr_b16 a[198:199], v113 offset:14592
    ds_read_b64_tr_b16 a[88:89], v112 offset:16384
    ds_read_b64_tr_b16 a[90:91], v112 offset:16640
    ds_read_b64_tr_b16 a[200:201], v113 offset:16384
    ds_read_b64_tr_b16 a[202:203], v113 offset:16640
    ds_read_b64_tr_b16 a[92:93], v112 offset:18432
    ds_read_b64_tr_b16 a[94:95], v112 offset:18688
    ds_read_b64_tr_b16 a[204:205], v113 offset:18432
    ds_read_b64_tr_b16 a[206:207], v113 offset:18688
    ds_read_b64_tr_b16 a[96:97], v112 offset:20480
    ds_read_b64_tr_b16 a[98:99], v112 offset:20736
    ds_read_b64_tr_b16 a[208:209], v113 offset:20480
    ds_read_b64_tr_b16 a[210:211], v113 offset:20736
    ds_read_b64_tr_b16 a[100:101], v112 offset:22528
    ds_read_b64_tr_b16 a[102:103], v112 offset:22784
    ds_read_b64_tr_b16 a[212:213], v113 offset:22528
    ds_read_b64_tr_b16 a[214:215], v113 offset:22784
    ds_read_b64_tr_b16 a[104:105], v112 offset:24576
    ds_read_b64_tr_b16 a[106:107], v112 offset:24832
    ds_read_b64_tr_b16 a[216:217], v113 offset:24576
    ds_read_b64_tr_b16 a[218:219], v113 offset:24832
    ds_read_b64_tr_b16 a[108:109], v112 offset:26624
    ds_read_b64_tr_b16 a[110:111], v112 offset:26880
    ds_read_b64_tr_b16 a[220:221], v113 offset:26624
    ds_read_b64_tr_b16 a[222:223], v113 offset:26880
    s_mov_b32 s13, 262144
    s_waitcnt vmcnt(0)
    v_cmp_ne_u32 vcc, s54, v11
    s_nop 0
    s_cbranch_vccnz L_poll_9
L_pollok_10:
    s_waitcnt lgkmcnt(0)
    s_add_u32 m0, s42, 0
    s_add_u32 s8, s55, 0
    buffer_load_dwordx4 v2, s[4:7], s8 offen offset:0 sc1 lds
    buffer_load_dwordx4 v2, s[4:7], s8 offen offset:1024 sc1 lds
    buffer_load_dwordx4 v2, s[4:7], s8 offen offset:2048 sc1 lds
    buffer_load_dwordx4 v2, s[4:7], s8 offen offset:3072 sc1 lds
    s_add_u32 m0, s42, 4096
    s_add_u32 s8, s55, 4096
    buffer_load_dwordx4 v2, s[4:7], s8 offen offset:0 sc1 lds
    buffer_load_dwordx4 v2, s[4:7], s8 offen offset:1024 sc1 lds
    buffer_load_dwordx4 v2, s[4:7], s8 offen offset:2048 sc1 lds
    buffer_load_dwordx4 v2, s[4:7], s8 offen offset:3072 sc1 lds
    s_waitcnt vmcnt(6)
    s_barrier
    ds_read_b128 v[172:175], v2 offset:0
    ds_read_b128 v[176:179], v2 offset:28672
    ds_read_b128 v[180:183], v8 offset:0
    ds_read_b128 v[184:187], v8 offset:28672
    s_waitcnt lgkmcnt(2)
    v_mfma_f32_32x32x16_bf16 v[44:59], a[0:3], v[172:175], 0
    ds_read_b128 v[188:191], v2 offset:1024
    ds_read_b128 v[192:195], v2 offset:29696
    s_add_u32 m0, s42, 8192
    s_add_u32 s8, s55, 8192
    buffer_load_dwordx4 v2, s[4:7], s8 offen offset:0 sc1 lds
    v_mfma_f32_32x32x16_bf16 v[60:75], a[0:3], v[176:179], 0
    ds_read_b128 v[196:199], v8 offset:1024
    ds_read_b128 v[200:203], v8 offset:29696
    s_waitcnt lgkmcnt(4)
    v_mfma_f32_32x32x16_bf16 v[76:91], a[0:3], v[180:183], 0
    s_add_u32 m0, s42, 8192
    s_nop 0
    buffer_load_dwordx4 v2, s[4:7], s8 offen offset:1024 sc1 lds
    v_mfma_f32_32x32x16_bf16 v[92:107], a[0:3], v[184:187], 0
    s_waitcnt vmcnt(6)
    s_barrier
    s_waitcnt lgkmcnt(2)
    v_mfma_f32_32x32x16_bf16 v[44:59], a[4:7], v[188:191], v[44:59]
    ds_read_b128 v[172:175], v2 offset:2048
    ds_read_b128 v[176:179], v2 offset:30720
    s_add_u32 m0, s42, 8192
    s_nop 0
    buffer_load_dwordx4 v2, s[4:7], s8 offen offset:2048 sc1 lds
    v_mfma_f32_32x32x16_bf16 v[60:75], a[4:7], v[192:195], v[60:75]
    ds_read_b128 v[180:183], v8 offset:2048
    ds_read_b128 v[184:187], v8 offset:30720
    s_waitcnt lgkmcnt(4)
    v_mfma_f32_32x32x16_bf16 v[76:91], a[4:7], v[196:199], v[76:91]
    s_add_u32 m0, s42, 8192
    s_nop 0
    buffer_load_dwordx4 v2, s[4:7], s8 offen offset:3072 sc1 lds
    v_mfma_f32_32x32x16_bf16 v[92:107], a[4:7], v[200:203], v[92:107]
    s_waitcnt lgkmcnt(2)
    v_mfma_f32_32x32x16_bf16 v[44:59], a[8:11], v[172:175], v[44:59]
    ds_read_b128 v[188:191], v2 offset:3072
    ds_read_b128 v[192:195], v2 offset:31744
    s_add_u32 m0, s42, 12288
    s_add_u32 s8, s55, 12288
    buffer_load_dwordx4 v2, s[4:7], s8 offen offset:0 sc1 lds
    v_mfma_f32_32x32x16_bf16 v[60:75], a[8:11], v[176:179], v[60:75]
    ds_read_b128 v[196:199], v8 offset:3072
    ds_read_b128 v[200:203], v8 offset:31744
    s_waitcnt lgkmcnt(4)
    v_mfma_f32_32x32x16_bf16 v[76:91], a[8:11], v[180:183], v[76:91]
    s_add_u32 m0, s42, 12288
    s_nop 0
    buffer_load_dwordx4 v2, s[4:7], s8 offen offset:1024 sc1 lds
    v_mfma_f32_32x32x16_bf16 v[92:107], a[8:11], v[184:187], v[92:107]
    s_waitcnt vmcnt(6)
    s_barrier
    s_waitcnt lgkmcnt(2)
    v_mfma_f32_32x32x16_bf16 v[44:59], a[12:15], v[188:191], v[44:59]
    ds_read_b128 v[172:175], v2 offset:4096
    ds_read_b128 v[176:179], v2 offset:32768
    s_add_u32 m0, s42, 12288
    s_nop 0
    buffer_load_dwordx4 v2, s[4:7], s8 offen offset:2048 sc1 lds
    v_mfma_f32_32x32x16_bf16 v[60:75], a[12:15], v[192:195], v[60:75]
    ds_read_b128 v[180:183], v8 offset:4096
    ds_read_b128 v[184:187], v8 offset:32768
    s_waitcnt lgkmcnt(4)
    v_mfma_f32_32x32x16_bf16 v[76:91], a[12:15], v[196:199], v[76:91]
    s_add_u32 m0, s42, 12288
    s_nop 0
    buffer_load_dwordx4 v2, s[4:7], s8 offen offset:3072 sc1 lds
    v_mfma_f32_32x32x16_bf16 v[92:107], a[12:15], v[200:203], v[92:107]
    s_waitcnt lgkmcnt(2)
    v_mfma_f32_32x32x16_bf16 v[44:59], a[16:19], v[172:175], v[44:59]
    ds_read_b128 v[188:191], v2 offset:5120
    ds_read_b128 v[192:195], v2 offset:33792
    s_add_u32 m0, s42, 16384
    s_add_u32 s8, s55, 16384
    buffer_load_dwordx4 v2, s[4:7], s8 offen offset:0 sc1 lds
    v_mfma_f32_32x32x16_bf16 v[60:75], a[16:19], v[176:179], v[60:75]
    ds_read_b128 v[196:199], v8 offset:5120
    ds_read_b128 v[200:203], v8 offset:33792
    s_waitcnt lgkmcnt(4)
    v_mfma_f32_32x32x16_bf16 v[76:91], a[16:19], v[180:183], v[76:91]
    s_add_u32 m0, s42, 16384
    s_nop 0
    buffer_load_dwordx4 v2, s[4:7], s8 offen offset:1024 sc1 lds
    v_mfma_f32_32x32x16_bf16 v[92:107], a[16:19], v[184:187], v[92:107]
    s_waitcnt lgkmcnt(2)
    v_mfma_f32_32x32x16_bf16 v[44:59], a[20:23], v[188:191], v[44:59]
    ds_read_b128 v[172:175], v2 offset:6144
    ds_read_b128 v[176:179], v2 offset:34816
    s_add_u32 m0, s42, 16384
    s_nop 0
    buffer_load_dwordx4 v2, s[4:7], s8 offen offset:2048 sc1 lds
    v_mfma_f32_32x32x16_bf16 v[60:75], a[20:23], v[192:195], v[60:75]
    ds_read_b128 v[180:183], v8 offset:6144
    ds_read_b128 v[184:187], v8 offset:34816
    s_waitcnt lgkmcnt(4)
    v_mfma_f32_32x32x16_bf16 v[76:91], a[20:23], v[196:199], v[76:91]
    s_add_u32 m0, s42, 16384
    s_nop 0
    buffer_load_dwordx4 v2, s[4:7], s8 offen offset:3072 sc1 lds
    v_mfma_f32_32x32x16_bf16 v[92:107], a[20:23], v[200:203], v[92:107]
    s_waitcnt lgkmcnt(2)
    v_mfma_f32_32x32x16_bf16 v[44:59], a[24:27], v[172:175], v[44:59]
    ds_read_b128 v[188:191], v2 offset:7168
    ds_read_b128 v[192:195], v2 offset:35840
    s_add_u32 m0, s42, 20480
    s_add_u32 s8, s55, 20480
    buffer_load_dwordx4 v2, s[4:7], s8 offen offset:0 sc1 lds
    v_mfma_f32_32x32x16_bf16 v[60:75], a[24:27], v[176:179], v[60:75]
    ds_read_b128 v[196:199], v8 offset:7168
    ds_read_b128 v[200:203], v8 offset:35840
    s_waitcnt lgkmcnt(4)
    v_mfma_f32_32x32x16_bf16 v[76:91], a[24:27], v[180:183], v[76:91]
    s_add_u32 m0, s42, 20480
    s_nop 0
    buffer_load_dwordx4 v2, s[4:7], s8 offen offset:1024 sc1 lds
    v_mfma_f32_32x32x16_bf16 v[92:107], a[24:27], v[184:187], v[92:107]
    s_waitcnt vmcnt(10)
    s_barrier
    s_waitcnt lgkmcnt(2)
    v_mfma_f32_32x32x16_bf16 v[44:59], a[28:31], v[188:191], v[44:59]
    ds_read_b128 v[172:175], v2 offset:8192
    ds_read_b128 v[176:179], v2 offset:36864
    s_add_u32 m0, s42, 20480
    s_nop 0
    buffer_load_dwordx4 v2, s[4:7], s8 offen offset:2048 sc1 lds
    v_mfma_f32_32x32x16_bf16 v[60:75], a[28:31], v[192:195], v[60:75]
    ds_read_b128 v[180:183], v8 offset:8192
    ds_read_b128 v[184:187], v8 offset:36864
    s_waitcnt lgkmcnt(4)
    v_mfma_f32_32x32x16_bf16 v[76:91], a[28:31], v[196:199], v[76:91]
    s_add_u32 m0, s42, 20480
    s_nop 0
    buffer_load_dwordx4 v2, s[4:7], s8 offen offset:3072 sc1 lds
    v_mfma_f32_32x32x16_bf16 v[92:107], a[28:31], v[200:203], v[92:107]
    s_waitcnt lgkmcnt(2)
    v_mfma_f32_32x32x16_bf16 v[44:59], a[32:35], v[172:175], v[44:59]
    ds_read_b128 v[188:191], v2 offset:9216
    ds_read_b128 v[192:195], v2 offset:37888
    s_add_u32 m0, s42, 24576
    s_add_u32 s8, s55, 24576
    buffer_load_dwordx4 v2, s[4:7], s8 offen offset:0 sc1 lds
    v_mfma_f32_32x32x16_bf16 v[60:75], a[32:35], v[176:179], v[60:75]
    ds_read_b128 v[196:199], v8 offset:9216
    ds_read_b128 v[200:203], v8 offset:37888
    s_waitcnt lgkmcnt(4)
    v_mfma_f32_32x32x16_bf16 v[76:91], a[32:35], v[180:183], v[76:91]
    s_add_u32 m0, s42, 24576
    s_nop 0
    buffer_load_dwordx4 v2, s[4:7], s8 offen offset:1024 sc1 lds
    v_mfma_f32_32x32x16_bf16 v[92:107], a[32:35], v[184:187], v[92:107]
    s_waitcnt lgkmcnt(2)
    v_mfma_f32_32x32x16_bf16 v[44:59], a[36:39], v[188:191], v[44:59]
    ds_read_b128 v[172:175], v2 offset:10240
    ds_read_b128 v[176:179], v2 offset:38912
    s_add_u32 m0, s42, 24576
    s_nop 0
    buffer_load_dwordx4 v2, s[4:7], s8 offen offset:2048 sc1 lds
    v_mfma_f32_32x32x16_bf16 v[60:75], a[36:39], v[192:195], v[60:75]
    ds_read_b128 v[180:183], v8 offset:10240
    ds_read_b128 v[184:187], v8 offset:38912
    s_waitcnt lgkmcnt(4)
    v_mfma_f32_32x32x16_bf16 v[76:91], a[36:39], v[196:199], v[76:91]
    s_add_u32 m0, s42, 24576
    s_nop 0
    buffer_load_dwordx4 v2, s[4:7], s8 offen offset:3072 sc1 lds
    v_mfma_f32_32x32x16_bf16 v[92:107], a[36:39], v[200:203], v[92:107]
    s_waitcnt lgkmcnt(2)
    v_mfma_f32_32x32x16_bf16 v[44:59], a[40:43], v[172:175], v[44:59]
    ds_read_b128 v[188:191], v2 offset:11264
    ds_read_b128 v[192:195], v2 offset:39936
    s_waitcnt vmcnt(39)
    ds_read_b64_tr_b16 a[0:1], v14 offset:0
    ds_read_b64_tr_b16 a[2:3], v14 offset:512
    v_mfma_f32_32x32x16_bf16 v[60:75], a[40:43], v[176:179], v[60:75]
    ds_read_b128 v[196:199], v8 offset:11264
    ds_read_b128 v[200:203], v8 offset:39936
    ds_read_b64_tr_b16 a[4:5], v15 offset:0
    ds_read_b64_tr_b16 a[6:7], v15 offset:512
    s_waitcnt lgkmcnt(8)
    v_mfma_f32_32x32x16_bf16 v[76:91], a[40:43], v[180:183], v[76:91]
    v_mfma_f32_32x32x16_bf16 v[92:107], a[40:43], v[184:187], v[92:107]
    s_waitcnt vmcnt(12)
    s_barrier
    s_waitcnt lgkmcnt(0)
    s_add_u32 m0, s57, 0
    s_add_u32 s62, s58, 688128
    buffer_load_dwordx4 v12, s[28:31], s62 offen lds
    s_waitcnt lgkmcnt(6)
    v_mfma_f32_32x32x16_bf16 v[44:59], a[44:47], v[188:191], v[44:59]
    ds_read_b128 v[172:175], v2 offset:12288
    ds_read_b128 v[176:179], v2 offset:40960
    s_add_u32 m0, s57, 1024
    s_nop 0
    buffer_load_dwordx4 v13, s[28:31], s62 offen lds
    v_mfma_f32_32x32x16_bf16 v[60:75], a[44:47], v[192:195], v[60:75]
    ds_read_b128 v[180:183], v8 offset:12288
    ds_read_b128 v[184:187], v8 offset:40960
    s_waitcnt vmcnt(39)
    ds_read_b64_tr_b16 a[8:9], v14 offset:2048
    ds_read_b64_tr_b16 a[10:11], v14 offset:2560
    s_waitcnt lgkmcnt(8)
    v_mfma_f32_32x32x16_bf16 v[76:91], a[44:47], v[196:199], v[76:91]
    ds_read_b64_tr_b16 a[12:13], v15 offset:2048
    ds_read_b64_tr_b16 a[14:15], v15 offset:2560
    v_mfma_f32_32x32x16_bf16 v[92:107], a[44:47], v[200:203], v[92:107]
    s_waitcnt lgkmcnt(6)
    v_mfma_f32_32x32x16_bf16 v[44:59], a[48:51], v[172:175], v[44:59]
    ds_read_b128 v[188:191], v2 offset:13312
    ds_read_b128 v[192:195], v2 offset:41984
    s_waitcnt lgkmcnt(2)
    s_add_u32 m0, s57, 2048
    s_add_u32 s62, s58, 802816
    buffer_load_dwordx4 v12, s[28:31], s62 offen lds
    v_mfma_f32_32x32x16_bf16 v[60:75], a[48:51], v[176:179], v[60:75]
    ds_read_b128 v[196:199], v8 offset:13312
    ds_read_b128 v[200:203], v8 offset:41984
    s_add_u32 m0, s57, 3072
    s_nop 0
    buffer_load_dwordx4 v13, s[28:31], s62 offen lds
    s_waitcnt lgkmcnt(8)
    v_mfma_f32_32x32x16_bf16 v[76:91], a[48:51], v[180:183], v[76:91]
    s_waitcnt vmcnt(39)
    ds_read_b64_tr_b16 a[16:17], v14 offset:4096
    ds_read_b64_tr_b16 a[18:19], v14 offset:4608
    v_mfma_f32_32x32x16_bf16 v[92:107], a[48:51], v[184:187], v[92:107]
    ds_read_b64_tr_b16 a[20:21], v15 offset:4096
    ds_read_b64_tr_b16 a[22:23], v15 offset:4608
    s_waitcnt lgkmcnt(6)
    v_mfma_f32_32x32x16_bf16 v[44:59], a[52:55], v[188:191], v[44:59]
    ds_read_b128 v[172:175], v2 offset:14336
    ds_read_b128 v[176:179], v2 offset:43008
    v_mfma_f32_32x32x16_bf16 v[60:75], a[52:55], v[192:195], v[60:75]
    ds_read_b128 v[180:183], v8 offset:14336
    ds_read_b128 v[184:187], v8 offset:43008
    s_waitcnt lgkmcnt(4)
    s_add_u32 m0, s57, 4096
    s_add_u32 s62, s58, 917504
    buffer_load_dwordx4 v12, s[28:31], s62 offen lds
    s_waitcnt lgkmcnt(8)
    v_mfma_f32_32x32x16_bf16 v[76:91], a[52:55], v[196:199], v[76:91]
    s_add_u32 m0, s57, 5120
    s_nop 0
    buffer_load_dwordx4 v13, s[28:31], s62 offen lds
    v_mfma_f32_32x32x16_bf16 v[92:107], a[52:55], v[200:203], v[92:107]
    s_waitcnt vmcnt(39)
    ds_read_b64_tr_b16 a[24:25], v14 offset:6144
    ds_read_b64_tr_b16 a[26:27], v14 offset:6656
    s_waitcnt lgkmcnt(4)
    v_mfma_f32_32x32x16_bf16 v[44:59], a[56:59], v[172:175], v[44:59]
    ds_read_b128 v[188:191], v2 offset:15360
    ds_read_b128 v[192:195], v2 offset:44032
    ds_read_b64_tr_b16 a[28:29], v15 offset:6144
    ds_read_b64_tr_b16 a[30:31], v15 offset:6656
    v_mfma_f32_32x32x16_bf16 v[60:75], a[56:59], v[176:179], v[60:75]
    ds_read_b128 v[196:199], v8 offset:15360
    ds_read_b128 v[200:203], v8 offset:44032
    s_waitcnt lgkmcnt(8)
    v_mfma_f32_32x32x16_bf16 v[76:91], a[56:59], v[180:183], v[76:91]
    s_waitcnt lgkmcnt(2)
    s_add_u32 m0, s57, 6144
    s_add_u32 s62, s58, 1032192
    buffer_load_dwordx4 v12, s[28:31], s62 offen lds
    v_mfma_f32_32x32x16_bf16 v[92:107], a[56:59], v[184:187], v[92:107]
    s_waitcnt vmcnt(15)
    s_barrier
    s_add_u32 m0, s57, 7168
    s_nop 0
    buffer_load_dwordx4 v13, s[28:31], s62 offen lds
    s_waitcnt lgkmcnt(4)
    v_mfma_f32_32x32x16_bf16 v[44:59], a[60:63], v[188:191], v[44:59]
    ds_read_b128 v[172:175], v2 offset:16384
    ds_read_b128 v[176:179], v2 offset:45056
    s_waitcnt vmcnt(39)
    ds_read_b64_tr_b16 a[32:33], v14 offset:8192
    ds_read_b64_tr_b16 a[34:35], v14 offset:8704
    v_mfma_f32_32x32x16_bf16 v[60:75], a[60:63], v[192:195], v[60:75]
    ds_read_b128 v[180:183], v8 offset:16384
    ds_read_b128 v[184:187], v8 offset:45056
    ds_read_b64_tr_b16 a[36:37], v15 offset:8192
    ds_read_b64_tr_b16 a[38:39], v15 offset:8704
    s_waitcnt lgkmcnt(8)
    v_mfma_f32_32x32x16_bf16 v[76:91], a[60:63], v[196:199], v[76:91]
    v_mfma_f32_32x32x16_bf16 v[92:107], a[60:63], v[200:203], v[92:107]
    s_waitcnt lgkmcnt(0)
    s_add_u32 m0, s57, 8192
    s_add_u32 s62, s58, 1146880
    buffer_load_dwordx4 v12, s[28:31], s62 offen lds
    s_waitcnt lgkmcnt(6)
    v_mfma_f32_32x32x16_bf16 v[44:59], a[64:67], v[172:175], v[44:59]
    ds_read_b128 v[188:191], v2 offset:17408
    ds_read_b128 v[192:195], v2 offset:46080
    s_add_u32 m0, s57, 9216
    s_nop 0
    buffer_load_dwordx4 v13, s[28:31], s62 offen lds
    v_mfma_f32_32x32x16_bf16 v[60:75], a[64:67], v[176:179], v[60:75]
    ds_read_b128 v[196:199], v8 offset:17408
    ds_read_b128 v[200:203], v8 offset:46080
    s_waitcnt vmcnt(39)
    ds_read_b64_tr_b16 a[40:41], v14 offset:10240
    ds_read_b64_tr_b16 a[42:43], v14 offset:10752
    s_waitcnt lgkmcnt(8)
    v_mfma_f32_32x32x16_bf16 v[76:91], a[64:67], v[180:183], v[76:91]
    ds_read_b64_tr_b16 a[44:45], v15 offset:10240
    ds_read_b64_tr_b16 a[46:47], v15 offset:10752
    v_mfma_f32_32x32x16_bf16 v[92:107], a[64:67], v[184:187], v[92:107]
    s_waitcnt lgkmcnt(6)
    v_mfma_f32_32x32x16_bf16 v[44:59], a[68:71], v[188:191], v[44:59]
    ds_read_b128 v[172:175], v2 offset:18432
    ds_read_b128 v[176:179], v2 offset:47104
    s_waitcnt lgkmcnt(2)
    s_add_u32 m0, s57, 10240
    s_add_u32 s62, s58, 1261568
    buffer_load_dwordx4 v12, s[28:31], s62 offen lds
    v_mfma_f32_32x32x16_bf16 v[60:75], a[68:71], v[192:195], v[60:75]
    ds_read_b128 v[180:183], v8 offset:18432
    ds_read_b128 v[184:187], v8 offset:47104
    s_add_u32 m0, s57, 11264
    s_nop 0
    buffer_load_dwordx4 v13, s[28:31], s62 offen lds
    s_waitcnt lgkmcnt(8)
    v_mfma_f32_32x32x16_bf16 v[76:91], a[68:71], v[196:199], v[76:91]
    s_waitcnt vmcnt(10)
    ds_read_b64_tr_b16 a[48:49], v14 offset:0
    ds_read_b64_tr_b16 a[50:51], v14 offset:512
    v_mfma_f32_32x32x16_bf16 v[92:107], a[68:71], v[200:203], v[92:107]
    ds_read_b64_tr_b16 a[52:53], v15 offset:0
    ds_read_b64_tr_b16 a[54:55], v15 offset:512
    s_waitcnt lgkmcnt(6)
    v_mfma_f32_32x32x16_bf16 v[44:59], a[72:75], v[172:175], v[44:59]
    ds_read_b128 v[188:191], v2 offset:19456
    ds_read_b128 v[192:195], v2 offset:48128
    v_mfma_f32_32x32x16_bf16 v[60:75], a[72:75], v[176:179], v[60:75]
    ds_read_b128 v[196:199], v8 offset:19456
    ds_read_b128 v[200:203], v8 offset:48128
    s_waitcnt lgkmcnt(8)
    v_mfma_f32_32x32x16_bf16 v[76:91], a[72:75], v[180:183], v[76:91]
    s_waitcnt lgkmcnt(4)
    s_add_u32 m0, s57, 0
    s_add_u32 s62, s58, 1376256
    buffer_load_dwordx4 v12, s[28:31], s62 offen lds
    v_mfma_f32_32x32x16_bf16 v[92:107], a[72:75], v[184:187], v[92:107]
    s_waitcnt vmcnt(17)
    s_barrier
    s_waitcnt vmcnt(9)
    ds_read_b64_tr_b16 a[56:57], v14 offset:2048
    ds_read_b64_tr_b16 a[58:59], v14 offset:2560
    s_waitcnt lgkmcnt(4)
    v_mfma_f32_32x32x16_bf16 v[44:59], a[76:79], v[188:191], v[44:59]
    ds_read_b128 v[172:175], v2 offset:20480
    ds_read_b128 v[176:179], v2 offset:49152
    s_add_u32 m0, s57, 1024
    s_nop 0
    buffer_load_dwordx4 v13, s[28:31], s62 offen lds
    v_mfma_f32_32x32x16_bf16 v[60:75], a[76:79], v[192:195], v[60:75]
    ds_read_b128 v[180:183], v8 offset:20480
    ds_read_b128 v[184:187], v8 offset:49152
    ds_read_b64_tr_b16 a[60:61], v15 offset:2048
    ds_read_b64_tr_b16 a[62:63], v15 offset:2560
    s_waitcnt lgkmcnt(8)
    v_mfma_f32_32x32x16_bf16 v[76:91], a[76:79], v[196:199], v[76:91]
    v_mfma_f32_32x32x16_bf16 v[92:107], a[76:79], v[200:203], v[92:107]
    s_waitcnt lgkmcnt(4)
    v_mfma_f32_32x32x16_bf16 v[44:59], a[80:83], v[172:175], v[44:59]
    ds_read_b128 v[188:191], v2 offset:21504
    ds_read_b128 v[192:195], v2 offset:50176
    s_waitcnt vmcnt(8)
    ds_read_b64_tr_b16 a[64:65], v14 offset:4096
    ds_read_b64_tr_b16 a[66:67], v14 offset:4608
    v_mfma_f32_32x32x16_bf16 v[60:75], a[80:83], v[176:179], v[60:75]
    ds_read_b128 v[196:199], v8 offset:21504
    ds_read_b128 v[200:203], v8 offset:50176
    ds_read_b64_tr_b16 a[68:69], v15 offset:4096
    ds_read_b64_tr_b16 a[70:71], v15 offset:4608
    s_add_u32 s3, s48, 14336
    buffer_store_dwordx4 v[4:7], v2, s[4:7], s3 offen sc1
    s_waitcnt lgkmcnt(10)
    v_mfma_f32_32x32x16_bf16 v[76:91], a[80:83], v[180:183], v[76:91]
    s_waitcnt lgkmcnt(8)
    s_add_u32 m0, s57, 2048
    s_add_u32 s62, s58, 1490944
    buffer_load_dwordx4 v12, s[28:31], s62 offen lds
    v_mfma_f32_32x32x16_bf16 v[92:107], a[80:83], v[184:187], v[92:107]
    s_add_u32 m0, s57, 3072
    s_nop 0
    buffer_load_dwordx4 v13, s[28:31], s62 offen lds
    s_waitcnt lgkmcnt(6)
    v_mfma_f32_32x32x16_bf16 v[44:59], a[84:87], v[188:191], v[44:59]
    ds_read_b128 v[172:175], v2 offset:22528
    ds_read_b128 v[176:179], v2 offset:51200
    s_add_u32 s3, s48, 129024
    buffer_store_dwordx4 v[4:7], v2, s[4:7], s3 offen sc1
    v_mfma_f32_32x32x16_bf16 v[60:75], a[84:87], v[192:195], v[60:75]
    ds_read_b128 v[180:183], v8 offset:22528
    ds_read_b128 v[184:187], v8 offset:51200
    s_waitcnt vmcnt(10)
    ds_read_b64_tr_b16 a[72:73], v14 offset:6144
    ds_read_b64_tr_b16 a[74:75], v14 offset:6656
    s_waitcnt lgkmcnt(8)
    v_mfma_f32_32x32x16_bf16 v[76:91], a[84:87], v[196:199], v[76:91]
    ds_read_b64_tr_b16 a[76:77], v15 offset:6144
    ds_read_b64_tr_b16 a[78:79], v15 offset:6656
    v_mfma_f32_32x32x16_bf16 v[92:107], a[84:87], v[200:203], v[92:107]
    s_waitcnt lgkmcnt(6)
    v_mfma_f32_32x32x16_bf16 v[44:59], a[88:91], v[172:175], v[44:59]
    ds_read_b128 v[188:191], v2 offset:23552
    ds_read_b128 v[192:195], v2 offset:52224
    s_add_u32 s3, s48, 243712
    buffer_store_dwordx4 v[4:7], v2, s[4:7], s3 offen sc1
    v_mfma_f32_32x32x16_bf16 v[60:75], a[88:91], v[176:179], v[60:75]
    ds_read_b128 v[196:199], v8 offset:23552
    ds_read_b128 v[200:203], v8 offset:52224
    s_waitcnt lgkmcnt(8)
    v_mfma_f32_32x32x16_bf16 v[76:91], a[88:91], v[180:183], v[76:91]
    s_waitcnt vmcnt(9)
    ds_read_b64_tr_b16 a[80:81], v14 offset:8192
    ds_read_b64_tr_b16 a[82:83], v14 offset:8704
    v_mfma_f32_32x32x16_bf16 v[92:107], a[88:91], v[184:187], v[92:107]
    s_waitcnt vmcnt(19)
    s_barrier
    s_waitcnt lgkmcnt(14)
    s_add_u32 m0, s57, 4096
    s_add_u32 s62, s58, 14336
    buffer_load_dwordx4 v12, s[28:31], s62 offen lds
    s_waitcnt lgkmcnt(4)
    v_mfma_f32_32x32x16_bf16 v[44:59], a[92:95], v[188:191], v[44:59]
    ds_read_b128 v[172:175], v2 offset:24576
    ds_read_b128 v[176:179], v2 offset:53248
    ds_read_b64_tr_b16 a[84:85], v15 offset:8192
    ds_read_b64_tr_b16 a[86:87], v15 offset:8704
    v_mfma_f32_32x32x16_bf16 v[60:75], a[92:95], v[192:195], v[60:75]
    ds_read_b128 v[180:183], v8 offset:24576
    ds_read_b128 v[184:187], v8 offset:53248
    s_add_u32 m0, s57, 5120
    s_nop 0
    buffer_load_dwordx4 v13, s[28:31], s62 offen lds
    s_add_u32 s3, s48, 358400
    buffer_store_dwordx4 v[4:7], v2, s[4:7], s3 offen sc1
    s_waitcnt lgkmcnt(8)
    v_mfma_f32_32x32x16_bf16 v[76:91], a[92:95], v[196:199], v[76:91]
    v_mfma_f32_32x32x16_bf16 v[92:107], a[92:95], v[200:203], v[92:107]
    s_waitcnt lgkmcnt(4)
    v_mfma_f32_32x32x16_bf16 v[44:59], a[96:99], v[172:175], v[44:59]
    ds_read_b128 v[188:191], v2 offset:25600
    ds_read_b128 v[192:195], v2 offset:54272
    s_waitcnt vmcnt(10)
    ds_read_b64_tr_b16 a[88:89], v14 offset:10240
    ds_read_b64_tr_b16 a[90:91], v14 offset:10752
    v_mfma_f32_32x32x16_bf16 v[60:75], a[96:99], v[176:179], v[60:75]
    ds_read_b128 v[196:199], v8 offset:25600
    ds_read_b128 v[200:203], v8 offset:54272
    ds_read_b64_tr_b16 a[92:93], v15 offset:10240
    ds_read_b64_tr_b16 a[94:95], v15 offset:10752
    s_waitcnt lgkmcnt(8)
    v_mfma_f32_32x32x16_bf16 v[76:91], a[96:99], v[180:183], v[76:91]
    s_waitcnt lgkmcnt(15)
    s_add_u32 m0, s57, 6144
    s_add_u32 s62, s58, 129024
    buffer_load_dwordx4 v12, s[28:31], s62 offen lds
    v_mfma_f32_32x32x16_bf16 v[92:107], a[96:99], v[184:187], v[92:107]
    s_add_u32 m0, s57, 7168
    s_nop 0
    buffer_load_dwordx4 v13, s[28:31], s62 offen lds
    s_waitcnt lgkmcnt(6)
    v_mfma_f32_32x32x16_bf16 v[44:59], a[100:103], v[188:191], v[44:59]
    ds_read_b128 v[172:175], v2 offset:26624
    ds_read_b128 v[176:179], v2 offset:55296
    v_mfma_f32_32x32x16_bf16 v[60:75], a[100:103], v[192:195], v[60:75]
    ds_read_b128 v[180:183], v8 offset:26624
    ds_read_b128 v[184:187], v8 offset:55296
    s_waitcnt lgkmcnt(6)
    v_mfma_f32_32x32x16_bf16 v[76:91], a[100:103], v[196:199], v[76:91]
    v_mfma_f32_32x32x16_bf16 v[92:107], a[100:103], v[200:203], v[92:107]
    s_waitcnt lgkmcnt(2)
    v_mfma_f32_32x32x16_bf16 v[44:59], a[104:107], v[172:175], v[44:59]
    ds_read_b128 v[188:191], v2 offset:27648
    ds_read_b128 v[192:195], v2 offset:56320
    s_waitcnt vmcnt(10)
    ds_read_b64_tr_b16 a[96:97], v14 offset:0
    ds_read_b64_tr_b16 a[98:99], v14 offset:512
    v_mfma_f32_32x32x16_bf16 v[60:75], a[104:107], v[176:179], v[60:75]
    ds_read_b128 v[196:199], v8 offset:27648
    ds_read_b128 v[200:203], v8 offset:56320
    ds_read_b64_tr_b16 a[100:101], v15 offset:0
    ds_read_b64_tr_b16 a[102:103], v15 offset:512
    s_mov_b32 s9, 15728640
    buffer_load_dword v11, v9, s[4:7], s9 offen sc1
    s_waitcnt lgkmcnt(8)
    v_mfma_f32_32x32x16_bf16 v[76:91], a[104:107], v[180:183], v[76:91]
    s_waitcnt lgkmcnt(15)
    s_add_u32 m0, s57, 8192
    s_add_u32 s62, s58, 243712
    buffer_load_dwordx4 v12, s[28:31], s62 offen lds
    v_mfma_f32_32x32x16_bf16 v[92:107], a[104:107], v[184:187], v[92:107]
    s_add_u32 m0, s57, 9216
    s_nop 0
    buffer_load_dwordx4 v13, s[28:31], s62 offen lds
    s_waitcnt lgkmcnt(6)
    v_mfma_f32_32x32x16_bf16 v[44:59], a[108:111], v[188:191], v[44:59]
    ds_read_b128 v[172:175], v2 offset:0
    ds_read_b128 v[176:179], v2 offset:28672
    v_mfma_f32_32x32x16_bf16 v[60:75], a[108:111], v[192:195], v[60:75]
    ds_read_b128 v[180:183], v8 offset:0
    ds_read_b128 v[184:187], v8 offset:28672
    s_waitcnt lgkmcnt(6)
    v_mfma_f32_32x32x16_bf16 v[76:91], a[108:111], v[196:199], v[76:91]
    v_mfma_f32_32x32x16_bf16 v[92:107], a[108:111], v[200:203], v[92:107]
    s_waitcnt lgkmcnt(2)
    v_mfma_f32_32x32x16_bf16 v[108:123], a[112:115], v[172:175], 0
    ds_read_b128 v[188:191], v2 offset:1024
    ds_read_b128 v[192:195], v2 offset:29696
    s_waitcnt vmcnt(10)
    ds_read_b64_tr_b16 a[104:105], v14 offset:2048
    ds_read_b64_tr_b16 a[106:107], v14 offset:2560
    v_mfma_f32_32x32x16_bf16 v[124:139], a[112:115], v[176:179], 0
    ds_read_b128 v[196:199], v8 offset:1024
    ds_read_b128 v[200:203], v8 offset:29696
    ds_read_b64_tr_b16 a[108:109], v15 offset:2048
    ds_read_b64_tr_b16 a[110:111], v15 offset:2560
    s_waitcnt vmcnt(5)
    s_waitcnt lgkmcnt(8)
    v_mfma_f32_32x32x16_bf16 v[140:155], a[112:115], v[180:183], 0
    s_waitcnt lgkmcnt(15)
    s_add_u32 m0, s57, 10240
    s_add_u32 s62, s58, 358400
    buffer_load_dwordx4 v12, s[28:31], s62 offen lds
    v_mul_f32 v44, v44, v48
    v_mul_f32 v45, v45, v49
    v_mfma_f32_32x32x16_bf16 v[156:171], a[112:115], v[184:187], 0
    s_add_u32 m0, s57, 11264
    s_nop 0
    buffer_load_dwordx4 v13, s[28:31], s62 offen lds
    v_mul_f32 v46, v46, v50
    v_mul_f32 v47, v47, v51
    v_mul_f32 v52, v52, v56
    v_mul_f32 v53, v53, v57
    s_waitcnt lgkmcnt(6)
    v_mfma_f32_32x32x16_bf16 v[108:123], a[116:119], v[188:191], v[108:123]
    ds_read_b128 v[172:175], v2 offset:2048
    ds_read_b128 v[176:179], v2 offset:30720
    v_mul_f32 v54, v54, v58
    v_mul_f32 v55, v55, v59
    v_cvt_pk_bf16_f32 v48, v44, v45
    v_mfma_f32_32x32x16_bf16 v[124:139], a[116:119], v[192:195], v[124:139]
    ds_read_b128 v[180:183], v8 offset:2048
    ds_read_b128 v[184:187], v8 offset:30720
    v_cvt_pk_bf16_f32 v49, v46, v47
    v_cvt_pk_bf16_f32 v50, v52, v53
    v_cvt_pk_bf16_f32 v51, v54, v55
    s_add_u32 s3, s48, 0
    buffer_store_dwordx4 v[48:51], v2, s[4:7], s3 offen sc1
    s_waitcnt lgkmcnt(6)
    v_mfma_f32_32x32x16_bf16 v[140:155], a[116:119], v[196:199], v[140:155]
    v_mul_f32 v60, v60, v64
    v_mul_f32 v61, v61, v65
    v_mul_f32 v62, v62, v66
    v_mul_f32 v63, v63, v67
    v_mul_f32 v68, v68, v72
    v_mfma_f32_32x32x16_bf16 v[156:171], a[116:119], v[200:203], v[156:171]
    v_mul_f32 v69, v69, v73
    v_mul_f32 v70, v70, v74
    v_mul_f32 v71, v71, v75
    v_cvt_pk_bf16_f32 v64, v60, v61
    v_cvt_pk_bf16_f32 v65, v62, v63
    v_cvt_pk_bf16_f32 v66, v68, v69
    s_waitcnt lgkmcnt(2)
    v_mfma_f32_32x32x16_bf16 v[108:123], a[120:123], v[172:175], v[108:123]
    ds_read_b128 v[188:191], v2 offset:3072
    ds_read_b128 v[192:195], v2 offset:31744
    s_waitcnt vmcnt(9)
    ds_read_b64_tr_b16 a[112:113], v14 offset:4096
    ds_read_b64_tr_b16 a[114:115], v14 offset:4608
    v_mfma_f32_32x32x16_bf16 v[124:139], a[120:123], v[176:179], v[124:139]
    ds_read_b128 v[196:199], v8 offset:3072
    ds_read_b128 v[200:203], v8 offset:31744
    ds_read_b64_tr_b16 a[116:117], v15 offset:4096
    ds_read_b64_tr_b16 a[118:119], v15 offset:4608
    v_cvt_pk_bf16_f32 v67, v70, v71
    s_add_u32 s3, s48, 114688
    buffer_store_dwordx4 v[64:67], v2, s[4:7], s3 offen sc1
    s_waitcnt lgkmcnt(8)
    v_mfma_f32_32x32x16_bf16 v[140:155], a[120:123], v[180:183], v[140:155]
    s_waitcnt lgkmcnt(15)
    s_add_u32 m0, s57, 0
    s_add_u32 s62, s58, 473088
    buffer_load_dwordx4 v12, s[28:31], s62 offen lds
    v_mul_f32 v76, v76, v80
    v_mul_f32 v77, v77, v81
    v_mfma_f32_32x32x16_bf16 v[156:171], a[120:123], v[184:187], v[156:171]
    s_add_u32 m0, s57, 1024
    s_nop 0
    buffer_load_dwordx4 v13, s[28:31], s62 offen lds
    v_mul_f32 v78, v78, v82
    v_mul_f32 v79, v79, v83
    v_mul_f32 v84, v84, v88
    v_mul_f32 v85, v85, v89
    s_waitcnt lgkmcnt(6)
    v_mfma_f32_32x32x16_bf16 v[108:123], a[124:127], v[188:191], v[108:123]
    ds_read_b128 v[172:175], v2 offset:4096
    ds_read_b128 v[176:179], v2 offset:32768
    v_mul_f32 v86, v86, v90
    v_mul_f32 v87, v87, v91
    v_cvt_pk_bf16_f32 v80, v76, v77
    v_mfma_f32_32x32x16_bf16 v[124:139], a[124:127], v[192:195], v[124:139]
    ds_read_b128 v[180:183], v8 offset:4096
    ds_read_b128 v[184:187], v8 offset:32768
    v_cvt_pk_bf16_f32 v81, v78, v79
    v_cvt_pk_bf16_f32 v82, v84, v85
    v_cvt_pk_bf16_f32 v83, v86, v87
    s_add_u32 s3, s48, 229376
    buffer_store_dwordx4 v[80:83], v2, s[4:7], s3 offen sc1
    s_waitcnt lgkmcnt(6)
    v_mfma_f32_32x32x16_bf16 v[140:155], a[124:127], v[196:199], v[140:155]
    v_mul_f32 v92, v92, v96
    v_mul_f32 v93, v93, v97
    v_mul_f32 v94, v94, v98
    v_mul_f32 v95, v95, v99
    v_mul_f32 v100, v100, v104
    v_mfma_f32_32x32x16_bf16 v[156:171], a[124:127], v[200:203], v[156:171]
    v_mul_f32 v101, v101, v105
    v_mul_f32 v102, v102, v106
    v_mul_f32 v103, v103, v107
    v_cvt_pk_bf16_f32 v96, v92, v93
    v_cvt_pk_bf16_f32 v97, v94, v95
    v_cvt_pk_bf16_f32 v98, v100, v101
    s_waitcnt lgkmcnt(2)
    v_mfma_f32_32x32x16_bf16 v[108:123], a[128:131], v[172:175], v[108:123]
    ds_read_b128 v[188:191], v2 offset:5120
    ds_read_b128 v[192:195], v2 offset:33792
    s_waitcnt vmcnt(10)
    ds_read_b64_tr_b16 a[120:121], v14 offset:6144
    ds_read_b64_tr_b16 a[122:123], v14 offset:6656
    v_mfma_f32_32x32x16_bf16 v[124:139], a[128:131], v[176:179], v[124:139]
    ds_read_b128 v[196:199], v8 offset:5120
    ds_read_b128 v[200:203], v8 offset:33792
    ds_read_b64_tr_b16 a[124:125], v15 offset:6144
    ds_read_b64_tr_b16 a[126:127], v15 offset:6656
    v_cvt_pk_bf16_f32 v99, v102, v103
    s_add_u32 s3, s48, 344064
    buffer_store_dwordx4 v[96:99], v2, s[4:7], s3 offen sc1
    s_waitcnt lgkmcnt(8)
    v_mfma_f32_32x32x16_bf16 v[140:155], a[128:131], v[180:183], v[140:155]
    s_waitcnt lgkmcnt(15)
    s_add_u32 m0, s57, 2048
    s_add_u32 s62, s58, 587776
    buffer_load_dwordx4 v12, s[28:31], s62 offen lds
    v_mfma_f32_32x32x16_bf16 v[156:171], a[128:131], v[184:187], v[156:171]
    s_add_u32 m0, s57, 3072
    s_nop 0
    buffer_load_dwordx4 v13, s[28:31], s62 offen lds
    s_waitcnt lgkmcnt(6)
    v_mfma_f32_32x32x16_bf16 v[108:123], a[132:135], v[188:191], v[108:123]
    ds_read_b128 v[172:175], v2 offset:6144
    ds_read_b128 v[176:179], v2 offset:34816
    s_waitcnt vmcnt(12)
    v_cmp_ne_u32 vcc, s54, v11
    s_nop 0
    s_cbranch_vccnz L_hfail_11
L_hok_12:
    v_mfma_f32_32x32x16_bf16 v[124:139], a[132:135], v[192:195], v[124:139]
    ds_read_b128 v[180:183], v8 offset:6144
    ds_read_b128 v[184:187], v8 offset:34816
    s_waitcnt lgkmcnt(6)
    v_mfma_f32_32x32x16_bf16 v[140:155], a[132:135], v[196:199], v[140:155]
    v_mfma_f32_32x32x16_bf16 v[156:171], a[132:135], v[200:203], v[156:171]
    s_waitcnt lgkmcnt(2)
    v_mfma_f32_32x32x16_bf16 v[108:123], a[136:139], v[172:175], v[108:123]
    ds_read_b128 v[188:191], v2 offset:7168
    ds_read_b128 v[192:195], v2 offset:35840
    s_waitcnt vmcnt(10)
    ds_read_b64_tr_b16 a[128:129], v14 offset:8192
    ds_read_b64_tr_b16 a[130:131], v14 offset:8704
    v_mfma_f32_32x32x16_bf16 v[124:139], a[136:139], v[176:179], v[124:139]
    ds_read_b128 v[196:199], v8 offset:7168
    ds_read_b128 v[200:203], v8 offset:35840
    ds_read_b64_tr_b16 a[132:133], v15 offset:8192
    ds_read_b64_tr_b16 a[134:135], v15 offset:8704
    s_waitcnt lgkmcnt(8)
    v_mfma_f32_32x32x16_bf16 v[140:155], a[136:139], v[180:183], v[140:155]
    s_waitcnt lgkmcnt(15)
    s_add_u32 m0, s57, 4096
    s_add_u32 s62, s58, 702464
    buffer_load_dwordx4 v12, s[28:31], s62 offen lds
    v_mfma_f32_32x32x16_bf16 v[156:171], a[136:139], v[184:187], v[156:171]
    s_add_u32 m0, s57, 5120
    s_nop 0
    buffer_load_dwordx4 v13, s[28:31], s62 offen lds
    s_waitcnt lgkmcnt(6)
    v_mfma_f32_32x32x16_bf16 v[108:123], a[140:143], v[188:191], v[108:123]
    ds_read_b128 v[172:175], v2 offset:8192
    ds_read_b128 v[176:179], v2 offset:36864
    v_mfma_f32_32x32x16_bf16 v[124:139], a[140:143], v[192:195], v[124:139]
    ds_read_b128 v[180:183], v8 offset:8192
    ds_read_b128 v[184:187], v8 offset:36864
    s_waitcnt lgkmcnt(6)
    v_mfma_f32_32x32x16_bf16 v[140:155], a[140:143], v[196:199], v[140:155]
    v_mfma_f32_32x32x16_bf16 v[156:171], a[140:143], v[200:203], v[156:171]
    s_waitcnt lgkmcnt(2)
    v_mfma_f32_32x32x16_bf16 v[108:123], a[144:147], v[172:175], v[108:123]
    ds_read_b128 v[188:191], v2 offset:9216
    ds_read_b128 v[192:195], v2 offset:37888
    s_waitcnt vmcnt(10)
    ds_read_b64_tr_b16 a[136:137], v14 offset:10240
    ds_read_b64_tr_b16 a[138:139], v14 offset:10752
    v_mfma_f32_32x32x16_bf16 v[124:139], a[144:147], v[176:179], v[124:139]
    ds_read_b128 v[196:199], v8 offset:9216
    ds_read_b128 v[200:203], v8 offset:37888
    ds_read_b64_tr_b16 a[140:141], v15 offset:10240
    ds_read_b64_tr_b16 a[142:143], v15 offset:10752
    s_waitcnt lgkmcnt(8)
    v_mfma_f32_32x32x16_bf16 v[140:155], a[144:147], v[180:183], v[140:155]
    s_waitcnt lgkmcnt(15)
    s_add_u32 m0, s57, 6144
    s_add_u32 s62, s58, 817152
    buffer_load_dwordx4 v12, s[28:31], s62 offen lds
    v_mfma_f32_32x32x16_bf16 v[156:171], a[144:147], v[184:187], v[156:171]
    s_add_u32 m0, s57, 7168
    s_nop 0
    buffer_load_dwordx4 v13, s[28:31], s62 offen lds
    s_waitcnt lgkmcnt(6)
    v_mfma_f32_32x32x16_bf16 v[108:123], a[148:151], v[188:191], v[108:123]
    ds_read_b128 v[172:175], v2 offset:10240
    ds_read_b128 v[176:179], v2 offset:38912
    v_mfma_f32_32x32x16_bf16 v[124:139], a[148:151], v[192:195], v[124:139]
    ds_read_b128 v[180:183], v8 offset:10240
    ds_read_b128 v[184:187], v8 offset:38912
    s_waitcnt lgkmcnt(6)
    v_mfma_f32_32x32x16_bf16 v[140:155], a[148:151], v[196:199], v[140:155]
    v_mfma_f32_32x32x16_bf16 v[156:171], a[148:151], v[200:203], v[156:171]
    s_waitcnt lgkmcnt(2)
    v_mfma_f32_32x32x16_bf16 v[108:123], a[152:155], v[172:175], v[108:123]
    ds_read_b128 v[188:191], v2 offset:11264
    ds_read_b128 v[192:195], v2 offset:39936
    s_waitcnt vmcnt(8)
    ds_read_b64_tr_b16 a[144:145], v14 offset:0
    ds_read_b64_tr_b16 a[146:147], v14 offset:512
    v_mfma_f32_32x32x16_bf16 v[124:139], a[152:155], v[176:179], v[124:139]
    ds_read_b128 v[196:199], v8 offset:11264
    ds_read_b128 v[200:203], v8 offset:39936
    ds_read_b64_tr_b16 a[148:149], v15 offset:0
    ds_read_b64_tr_b16 a[150:151], v15 offset:512
    s_waitcnt lgkmcnt(8)
    v_mfma_f32_32x32x16_bf16 v[140:155], a[152:155], v[180:183], v[140:155]
    s_waitcnt lgkmcnt(15)
    s_add_u32 m0, s57, 8192
    s_add_u32 s62, s58, 931840
    buffer_load_dwordx4 v12, s[28:31], s62 offen lds
    v_mfma_f32_32x32x16_bf16 v[156:171], a[152:155], v[184:187], v[156:171]
    s_add_u32 m0, s57, 9216
    s_nop 0
    buffer_load_dwordx4 v13, s[28:31], s62 offen lds
    s_waitcnt lgkmcnt(6)
    v_mfma_f32_32x32x16_bf16 v[108:123], a[156:159], v[188:191], v[108:123]
    ds_read_b128 v[172:175], v2 offset:12288
    ds_read_b128 v[176:179], v2 offset:40960
    v_mfma_f32_32x32x16_bf16 v[124:139], a[156:159], v[192:195], v[124:139]
    ds_read_b128 v[180:183], v8 offset:12288
    ds_read_b128 v[184:187], v8 offset:40960
    s_waitcnt lgkmcnt(6)
    v_mfma_f32_32x32x16_bf16 v[140:155], a[156:159], v[196:199], v[140:155]
    v_mfma_f32_32x32x16_bf16 v[156:171], a[156:159], v[200:203], v[156:171]
    s_waitcnt lgkmcnt(2)
    v_mfma_f32_32x32x16_bf16 v[108:123], a[160:163], v[172:175], v[108:123]
    ds_read_b128 v[188:191], v2 offset:13312
    ds_read_b128 v[192:195], v2 offset:41984
    s_waitcnt vmcnt(6)
    ds_read_b64_tr_b16 a[152:153], v14 offset:2048
    ds_read_b64_tr_b16 a[154:155], v14 offset:2560
    v_mfma_f32_32x32x16_bf16 v[124:139], a[160:163], v[176:179], v[124:139]
    ds_read_b128 v[196:199], v8 offset:13312
    ds_read_b128 v[200:203], v8 offset:41984
    ds_read_b64_tr_b16 a[156:157], v15 offset:2048
    ds_read_b64_tr_b16 a[158:159], v15 offset:2560
    s_waitcnt lgkmcnt(8)
    v_mfma_f32_32x32x16_bf16 v[140:155], a[160:163], v[180:183], v[140:155]
    s_waitcnt lgkmcnt(15)
    s_add_u32 m0, s57, 10240
    s_add_u32 s62, s58, 1046528
    buffer_load_dwordx4 v12, s[28:31], s62 offen lds
    v_mfma_f32_32x32x16_bf16 v[156:171], a[160:163], v[184:187], v[156:171]
    s_add_u32 m0, s57, 11264
    s_nop 0
    buffer_load_dwordx4 v13, s[28:31], s62 offen lds
    s_waitcnt lgkmcnt(6)
    v_mfma_f32_32x32x16_bf16 v[108:123], a[164:167], v[188:191], v[108:123]
    ds_read_b128 v[172:175], v2 offset:14336
    ds_read_b128 v[176:179], v2 offset:43008
    v_mfma_f32_32x32x16_bf16 v[124:139], a[164:167], v[192:195], v[124:139]
    ds_read_b128 v[180:183], v8 offset:14336
    ds_read_b128 v[184:187], v8 offset:43008
    s_waitcnt lgkmcnt(6)
    v_mfma_f32_32x32x16_bf16 v[140:155], a[164:167], v[196:199], v[140:155]
    v_mfma_f32_32x32x16_bf16 v[156:171], a[164:167], v[200:203], v[156:171]
    s_waitcnt lgkmcnt(2)
    v_mfma_f32_32x32x16_bf16 v[108:123], a[168:171], v[172:175], v[108:123]
    ds_read_b128 v[188:191], v2 offset:15360
    ds_read_b128 v[192:195], v2 offset:44032
    s_waitcnt vmcnt(6)
    ds_read_b64_tr_b16 a[160:161], v14 offset:4096
    ds_read_b64_tr_b16 a[162:163], v14 offset:4608
    v_mfma_f32_32x32x16_bf16 v[124:139], a[168:171], v[176:179], v[124:139]
    ds_read_b128 v[196:199], v8 offset:15360
    ds_read_b128 v[200:203], v8 offset:44032
    ds_read_b64_tr_b16 a[164:165], v15 offset:4096
    ds_read_b64_tr_b16 a[166:167], v15 offset:4608
    s_waitcnt lgkmcnt(8)
    v_mfma_f32_32x32x16_bf16 v[140:155], a[168:171], v[180:183], v[140:155]
    s_waitcnt lgkmcnt(15)
    s_add_u32 m0, s57, 0
    s_add_u32 s62, s58, 1161216
    buffer_load_dwordx4 v12, s[28:31], s62 offen lds
    v_mfma_f32_32x32x16_bf16 v[156:171], a[168:171], v[184:187], v[156:171]
    s_add_u32 m0, s57, 1024
    s_nop 0
    buffer_load_dwordx4 v13, s[28:31], s62 offen lds
    s_waitcnt lgkmcnt(6)
    v_mfma_f32_32x32x16_bf16 v[108:123], a[172:175], v[188:191], v[108:123]
    ds_read_b128 v[172:175], v2 offset:16384
    ds_read_b128 v[176:179], v2 offset:45056
    v_mfma_f32_32x32x16_bf16 v[124:139], a[172:175], v[192:195], v[124:139]
    ds_read_b128 v[180:183], v8 offset:16384
    ds_read_b128 v[184:187], v8 offset:45056
    s_waitcnt lgkmcnt(6)
    v_mfma_f32_32x32x16_bf16 v[140:155], a[172:175], v[196:199], v[140:155]
    v_mfma_f32_32x32x16_bf16 v[156:171], a[172:175], v[200:203], v[156:171]
    s_waitcnt vmcnt(12)
    s_waitcnt lgkmcnt(2)
    v_mfma_f32_32x32x16_bf16 v[108:123], a[176:179], v[172:175], v[108:123]
    ds_read_b128 v[188:191], v2 offset:17408
    ds_read_b128 v[192:195], v2 offset:46080
    s_waitcnt vmcnt(6)
    ds_read_b64_tr_b16 a[168:169], v14 offset:6144
    ds_read_b64_tr_b16 a[170:171], v14 offset:6656
    v_mfma_f32_32x32x16_bf16 v[124:139], a[176:179], v[176:179], v[124:139]
    ds_read_b128 v[196:199], v8 offset:17408
    ds_read_b128 v[200:203], v8 offset:46080
    ds_read_b64_tr_b16 a[172:173], v15 offset:6144
    ds_read_b64_tr_b16 a[174:175], v15 offset:6656
    s_add_u32 s10, s59, 0
    buffer_load_dwordx4 v[44:47], v16, s[4:7], s10 offen offset:0 sc1
    s_waitcnt lgkmcnt(8)
    v_mfma_f32_32x32x16_bf16 v[140:155], a[176:179], v[180:183], v[140:155]
    s_waitcnt lgkmcnt(15)
    s_add_u32 m0, s57, 2048
    s_add_u32 s62, s58, 1275904
    buffer_load_dwordx4 v12, s[28:31], s62 offen lds
    buffer_load_dwordx4 v[48:51], v17, s[4:7], s10 offen offset:0 sc1
    v_mfma_f32_32x32x16_bf16 v[156:171], a[176:179], v[184:187], v[156:171]
    s_add_u32 m0, s57, 3072
    s_nop 0
    buffer_load_dwordx4 v13, s[28:31], s62 offen lds
    s_waitcnt lgkmcnt(6)
    v_mfma_f32_32x32x16_bf16 v[108:123], a[180:183], v[188:191], v[108:123]
    ds_read_b128 v[172:175], v2 offset:18432
    ds_read_b128 v[176:179], v2 offset:47104
    buffer_load_dwordx4 v[52:55], v16, s[4:7], s10 offen offset:1024 sc1
    v_mfma_f32_32x32x16_bf16 v[124:139], a[180:183], v[192:195], v[124:139]
    ds_read_b128 v[180:183], v8 offset:18432
    ds_read_b128 v[184:187], v8 offset:47104
    s_waitcnt lgkmcnt(6)
    v_mfma_f32_32x32x16_bf16 v[140:155], a[180:183], v[196:199], v[140:155]
    buffer_load_dwordx4 v[56:59], v17, s[4:7], s10 offen offset:1024 sc1
    v_mfma_f32_32x32x16_bf16 v[156:171], a[180:183], v[200:203], v[156:171]
    s_waitcnt lgkmcnt(2)
    v_mfma_f32_32x32x16_bf16 v[108:123], a[184:187], v[172:175], v[108:123]
    ds_read_b128 v[188:191], v2 offset:19456
    ds_read_b128 v[192:195], v2 offset:48128
    s_waitcnt vmcnt(10)
    ds_read_b64_tr_b16 a[176:177], v14 offset:8192
    ds_read_b64_tr_b16 a[178:179], v14 offset:8704
    v_mfma_f32_32x32x16_bf16 v[124:139], a[184:187], v[176:179], v[124:139]
    ds_read_b128 v[196:199], v8 offset:19456
    ds_read_b128 v[200:203], v8 offset:48128
    ds_read_b64_tr_b16 a[180:181], v15 offset:8192
    ds_read_b64_tr_b16 a[182:183], v15 offset:8704
    buffer_load_dwordx4 v[60:63], v16, s[4:7], s10 offen offset:2048 sc1
    s_waitcnt lgkmcnt(8)
    v_mfma_f32_32x32x16_bf16 v[140:155], a[184:187], v[180:183], v[140:155]
    s_waitcnt lgkmcnt(15)
    s_add_u32 m0, s57, 4096
    s_add_u32 s62, s58, 1390592
    buffer_load_dwordx4 v12, s[28:31], s62 offen lds
    buffer_load_dwordx4 v[64:67], v17, s[4:7], s10 offen offset:2048 sc1
    v_mfma_f32_32x32x16_bf16 v[156:171], a[184:187], v[184:187], v[156:171]
    s_add_u32 m0, s57, 5120
    s_nop 0
    buffer_load_dwordx4 v13, s[28:31], s62 offen lds
    s_waitcnt lgkmcnt(6)
    v_mfma_f32_32x32x16_bf16 v[108:123], a[188:191], v[188:191], v[108:123]
    ds_read_b128 v[172:175], v2 offset:20480
    ds_read_b128 v[176:179], v2 offset:49152
    buffer_load_dwordx4 v[68:71], v16, s[4:7], s10 offen offset:3072 sc1
    v_mfma_f32_32x32x16_bf16 v[124:139], a[188:191], v[192:195], v[124:139]
    ds_read_b128 v[180:183], v8 offset:20480
    ds_read_b128 v[184:187], v8 offset:49152
    s_waitcnt lgkmcnt(6)
    v_mfma_f32_32x32x16_bf16 v[140:155], a[188:191], v[196:199], v[140:155]
    buffer_load_dwordx4 v[72:75], v17, s[4:7], s10 offen offset:3072 sc1
    v_mfma_f32_32x32x16_bf16 v[156:171], a[188:191], v[200:203], v[156:171]
    s_waitcnt lgkmcnt(2)
    v_mfma_f32_32x32x16_bf16 v[108:123], a[192:195], v[172:175], v[108:123]
    ds_read_b128 v[188:191], v2 offset:21504
    ds_read_b128 v[192:195], v2 offset:50176
    s_waitcnt vmcnt(14)
    ds_read_b64_tr_b16 a[184:185], v14 offset:10240
    ds_read_b64_tr_b16 a[186:187], v14 offset:10752
    v_mfma_f32_32x32x16_bf16 v[124:139], a[192:195], v[176:179], v[124:139]
    ds_read_b128 v[196:199], v8 offset:21504
    ds_read_b128 v[200:203], v8 offset:50176
    ds_read_b64_tr_b16 a[188:189], v15 offset:10240
    ds_read_b64_tr_b16 a[190:191], v15 offset:10752
    s_add_u32 s10, s59, 4096
    buffer_load_dwordx4 v[76:79], v16, s[4:7], s10 offen offset:0 sc1
    s_waitcnt lgkmcnt(8)
    v_mfma_f32_32x32x16_bf16 v[140:155], a[192:195], v[180:183], v[140:155]
    s_waitcnt lgkmcnt(15)
    s_add_u32 m0, s57, 6144
    s_add_u32 s62, s58, 1505280
    buffer_load_dwordx4 v12, s[28:31], s62 offen lds
    buffer_load_dwordx4 v[80:83], v17, s[4:7], s10 offen offset:0 sc1
    v_mfma_f32_32x32x16_bf16 v[156:171], a[192:195], v[184:187], v[156:171]
    s_add_u32 m0, s57, 7168
    s_nop 0
    buffer_load_dwordx4 v13, s[28:31], s62 offen lds
    s_waitcnt lgkmcnt(6)
    v_mfma_f32_32x32x16_bf16 v[108:123], a[196:199], v[188:191], v[108:123]
    ds_read_b128 v[172:175], v2 offset:22528
    ds_read_b128 v[176:179], v2 offset:51200
    buffer_load_dwordx4 v[84:87], v16, s[4:7], s10 offen offset:1024 sc1
    v_mfma_f32_32x32x16_bf16 v[124:139], a[196:199], v[192:195], v[124:139]
    ds_read_b128 v[180:183], v8 offset:22528
    ds_read_b128 v[184:187], v8 offset:51200
    s_waitcnt lgkmcnt(6)
    v_mfma_f32_32x32x16_bf16 v[140:155], a[196:199], v[196:199], v[140:155]
    buffer_load_dwordx4 v[88:91], v17, s[4:7], s10 offen offset:1024 sc1
    v_mfma_f32_32x32x16_bf16 v[156:171], a[196:199], v[200:203], v[156:171]
    s_waitcnt lgkmcnt(2)
    v_mfma_f32_32x32x16_bf16 v[108:123], a[200:203], v[172:175], v[108:123]
    ds_read_b128 v[188:191], v2 offset:23552
    ds_read_b128 v[192:195], v2 offset:52224
    s_waitcnt vmcnt(18)
    ds_read_b64_tr_b16 a[192:193], v14 offset:0
    ds_read_b64_tr_b16 a[194:195], v14 offset:512
    v_mfma_f32_32x32x16_bf16 v[124:139], a[200:203], v[176:179], v[124:139]
    ds_read_b128 v[196:199], v8 offset:23552
    ds_read_b128 v[200:203], v8 offset:52224
    ds_read_b64_tr_b16 a[196:197], v15 offset:0
    ds_read_b64_tr_b16 a[198:199], v15 offset:512
    buffer_load_dwordx4 v[92:95], v16, s[4:7], s10 offen offset:2048 sc1
    s_waitcnt lgkmcnt(8)
    v_mfma_f32_32x32x16_bf16 v[140:155], a[200:203], v[180:183], v[140:155]
    buffer_load_dwordx4 v[96:99], v17, s[4:7], s10 offen offset:2048 sc1
    v_mfma_f32_32x32x16_bf16 v[156:171], a[200:203], v[184:187], v[156:171]
    s_waitcnt lgkmcnt(6)
    v_mfma_f32_32x32x16_bf16 v[108:123], a[204:207], v[188:191], v[108:123]
    ds_read_b128 v[172:175], v2 offset:24576
    ds_read_b128 v[176:179], v2 offset:53248
    buffer_load_dwordx4 v[100:103], v16, s[4:7], s10 offen offset:3072 sc1
    v_mfma_f32_32x32x16_bf16 v[124:139], a[204:207], v[192:195], v[124:139]
    ds_read_b128 v[180:183], v8 offset:24576
    ds_read_b128 v[184:187], v8 offset:53248
    s_waitcnt lgkmcnt(6)
    v_mfma_f32_32x32x16_bf16 v[140:155], a[204:207], v[196:199], v[140:155]
    buffer_load_dwordx4 v[104:107], v17, s[4:7], s10 offen offset:3072 sc1
    v_mfma_f32_32x32x16_bf16 v[156:171], a[204:207], v[200:203], v[156:171]
    s_waitcnt lgkmcnt(2)
    v_mfma_f32_32x32x16_bf16 v[108:123], a[208:211], v[172:175], v[108:123]
    ds_read_b128 v[188:191], v2 offset:25600
    ds_read_b128 v[192:195], v2 offset:54272
    s_waitcnt vmcnt(18)
    ds_read_b64_tr_b16 a[200:201], v14 offset:2048
    ds_read_b64_tr_b16 a[202:203], v14 offset:2560
    v_mfma_f32_32x32x16_bf16 v[124:139], a[208:211], v[176:179], v[124:139]
    ds_read_b128 v[196:199], v8 offset:25600
    ds_read_b128 v[200:203], v8 offset:54272
    ds_read_b64_tr_b16 a[204:205], v15 offset:2048
    ds_read_b64_tr_b16 a[206:207], v15 offset:2560
    s_add_u32 s10, s59, 8192
    buffer_load_dwordx4 v[204:207], v16, s[4:7], s10 offen offset:0 sc1
    s_waitcnt lgkmcnt(8)
    v_mfma_f32_32x32x16_bf16 v[140:155], a[208:211], v[180:183], v[140:155]
    buffer_load_dwordx4 v[208:211], v17, s[4:7], s10 offen offset:0 sc1
    v_mfma_f32_32x32x16_bf16 v[156:171], a[208:211], v[184:187], v[156:171]
    s_waitcnt lgkmcnt(6)
    v_mfma_f32_32x32x16_bf16 v[108:123], a[212:215], v[188:191], v[108:123]
    ds_read_b128 v[172:175], v2 offset:26624
    ds_read_b128 v[176:179], v2 offset:55296
    v_mfma_f32_32x32x16_bf16 v[124:139], a[212:215], v[192:195], v[124:139]
    ds_read_b128 v[180:183], v8 offset:26624
    ds_read_b128 v[184:187], v8 offset:55296
    s_waitcnt lgkmcnt(6)
    v_mfma_f32_32x32x16_bf16 v[140:155], a[212:215], v[196:199], v[140:155]
    v_mfma_f32_32x32x16_bf16 v[156:171], a[212:215], v[200:203], v[156:171]
    s_waitcnt lgkmcnt(2)
    v_mfma_f32_32x32x16_bf16 v[108:123], a[216:219], v[172:175], v[108:123]
    ds_read_b128 v[188:191], v2 offset:27648
    ds_read_b128 v[192:195], v2 offset:56320
    s_waitcnt vmcnt(14)
    ds_read_b64_tr_b16 a[208:209], v14 offset:4096
    ds_read_b64_tr_b16 a[210:211], v14 offset:4608
    v_mfma_f32_32x32x16_bf16 v[124:139], a[216:219], v[176:179], v[124:139]
    ds_read_b128 v[196:199], v8 offset:27648
    ds_read_b128 v[200:203], v8 offset:56320
    ds_read_b64_tr_b16 a[212:213], v15 offset:4096
    ds_read_b64_tr_b16 a[214:215], v15 offset:4608
    s_waitcnt lgkmcnt(8)
    v_mfma_f32_32x32x16_bf16 v[140:155], a[216:219], v[180:183], v[140:155]
    v_mfma_f32_32x32x16_bf16 v[156:171], a[216:219], v[184:187], v[156:171]
    s_waitcnt lgkmcnt(6)
    v_mfma_f32_32x32x16_bf16 v[108:123], a[220:223], v[188:191], v[108:123]
    v_mfma_f32_32x32x16_bf16 v[124:139], a[220:223], v[192:195], v[124:139]
    s_waitcnt lgkmcnt(2)
    v_mfma_f32_32x32x16_bf16 v[140:155], a[220:223], v[196:199], v[140:155]
    v_mfma_f32_32x32x16_bf16 v[156:171], a[220:223], v[200:203], v[156:171]
    s_nop 7
    v_pk_mul_f32 v[108:109], v[108:109], v[112:113]
    v_pk_mul_f32 v[110:111], v[110:111], v[114:115]
    v_pk_mul_f32 v[116:117], v[116:117], v[120:121]
    v_pk_mul_f32 v[118:119], v[118:119], v[122:123]
    v_cvt_pk_bf16_f32 v172, v108, v109
    v_cvt_pk_bf16_f32 v173, v110, v111
    v_cvt_pk_bf16_f32 v174, v116, v117
    v_cvt_pk_bf16_f32 v175, v118, v119
    s_add_u32 s3, s48, 14336
    buffer_store_dwordx4 v[172:175], v2, s[4:7], s3 offen sc1
    v_pk_mul_f32 v[124:125], v[124:125], v[128:129]
    v_pk_mul_f32 v[126:127], v[126:127], v[130:131]
    v_pk_mul_f32 v[132:133], v[132:133], v[136:137]
    v_pk_mul_f32 v[134:135], v[134:135], v[138:139]
    v_cvt_pk_bf16_f32 v176, v124, v125
    v_cvt_pk_bf16_f32 v177, v126, v127
    v_cvt_pk_bf16_f32 v178, v132, v133
    v_cvt_pk_bf16_f32 v179, v134, v135
    s_add_u32 s3, s48, 129024
    buffer_store_dwordx4 v[176:179], v2, s[4:7], s3 offen sc1
    v_pk_mul_f32 v[140:141], v[140:141], v[144:145]
    v_pk_mul_f32 v[142:143], v[142:143], v[146:147]
    v_pk_mul_f32 v[148:149], v[148:149], v[152:153]
    v_pk_mul_f32 v[150:151], v[150:151], v[154:155]
    v_cvt_pk_bf16_f32 v180, v140, v141
    v_cvt_pk_bf16_f32 v181, v142, v143
    v_cvt_pk_bf16_f32 v182, v148, v149
    v_cvt_pk_bf16_f32 v183, v150, v151
    s_add_u32 s3, s48, 243712
    buffer_store_dwordx4 v[180:183], v2, s[4:7], s3 offen sc1
    v_pk_mul_f32 v[156:157], v[156:157], v[160:161]
    v_pk_mul_f32 v[158:159], v[158:159], v[162:163]
    v_pk_mul_f32 v[164:165], v[164:165], v[168:169]
    v_pk_mul_f32 v[166:167], v[166:167], v[170:171]
    v_cvt_pk_bf16_f32 v184, v156, v157
    v_cvt_pk_bf16_f32 v185, v158, v159
    v_cvt_pk_bf16_f32 v186, v164, v165
    v_cvt_pk_bf16_f32 v187, v166, v167
    s_add_u32 s3, s48, 358400
    buffer_store_dwordx4 v[184:187], v2, s[4:7], s3 offen sc1
    buffer_load_dwordx4 v[4:7], v19, s[4:7], s61 offen sc1
    buffer_load_dwordx4 v[200:203], v19, s[4:7], s61 offen offset:16 sc1
    s_waitcnt lgkmcnt(0)
    s_mov_b32 s13, 262144
    s_waitcnt vmcnt(29)
    v_max3_u32 v11, v44, v45, v46
    v_max_u32 v11, v11, v47
    v_cmp_eq_u32 vcc, -1, v11
    s_nop 0
    s_cbranch_vccnz L_hre_13
L_hre_ok_14:
    s_waitcnt vmcnt(14)
    ds_read_b64_tr_b16 a[216:217], v14 offset:6144
    ds_read_b64_tr_b16 a[218:219], v14 offset:6656
    ds_read_b64_tr_b16 a[220:221], v15 offset:6144
    ds_read_b64_tr_b16 a[222:223], v15 offset:6656
    v_mfma_f32_32x32x16_bf16 v[124:139], a[4:7], v[44:47], 0
    s_waitcnt vmcnt(27)
    v_max3_u32 v11, v48, v49, v50
    v_max_u32 v11, v11, v51
    v_cmp_eq_u32 vcc, -1, v11
    v_mfma_f32_32x32x16_bf16 v[108:123], a[0:3], v[44:47], 0
    s_cbranch_vccnz L_hre_15
L_hre_ok_16:
    v_mfma_f32_32x32x16_bf16 v[140:155], a[0:3], v[48:51], 0
    s_waitcnt vmcnt(25)
    v_max3_u32 v11, v52, v53, v54
    v_max_u32 v11, v11, v55
    v_cmp_eq_u32 vcc, -1, v11
    v_mfma_f32_32x32x16_bf16 v[156:171], a[4:7], v[48:51], 0
    s_cbranch_vccnz L_hre_17
L_hre_ok_18:
    v_mfma_f32_32x32x16_bf16 v[124:139], a[12:15], v[52:55], v[124:139]
    s_waitcnt vmcnt(24)
    v_max3_u32 v11, v56, v57, v58
    v_max_u32 v11, v11, v59
    v_cmp_eq_u32 vcc, -1, v11
    v_mfma_f32_32x32x16_bf16 v[108:123], a[8:11], v[52:55], v[108:123]
    s_cbranch_vccnz L_hre_19
L_hre_ok_20:
    v_mfma_f32_32x32x16_bf16 v[140:155], a[8:11], v[56:59], v[140:155]
    s_waitcnt vmcnt(23)
    v_max3_u32 v11, v60, v61, v62
    v_max_u32 v11, v11, v63
    v_cmp_eq_u32 vcc, -1, v11
    v_mfma_f32_32x32x16_bf16 v[156:171], a[12:15], v[56:59], v[156:171]
    s_cbranch_vccnz L_hre_21
L_hre_ok_22:
    v_mfma_f32_32x32x16_bf16 v[124:139], a[20:23], v[60:63], v[124:139]
    s_waitcnt vmcnt(21)
    v_max3_u32 v11, v64, v65, v66
    v_max_u32 v11, v11, v67
    v_cmp_eq_u32 vcc, -1, v11
    v_mfma_f32_32x32x16_bf16 v[108:123], a[16:19], v[60:63], v[108:123]
    s_cbranch_vccnz L_hre_23
L_hre_ok_24:
    v_mfma_f32_32x32x16_bf16 v[140:155], a[16:19], v[64:67], v[140:155]
    s_waitcnt vmcnt(19)
    v_max3_u32 v11, v68, v69, v70
    v_max_u32 v11, v11, v71
    v_cmp_eq_u32 vcc, -1, v11
    v_mfma_f32_32x32x16_bf16 v[156:171], a[20:23], v[64:67], v[156:171]
    s_cbranch_vccnz L_hre_25
L_hre_ok_26:
    buffer_load_dwordx4 v[212:215], v16, s[4:7], s10 offen offset:1024 sc1
    v_mfma_f32_32x32x16_bf16 v[124:139], a[28:31], v[68:71], v[124:139]
    s_waitcnt vmcnt(19)
    v_max3_u32 v11, v72, v73, v74
    v_max_u32 v11, v11, v75
    v_cmp_eq_u32 vcc, -1, v11
    v_mfma_f32_32x32x16_bf16 v[108:123], a[24:27], v[68:71], v[108:123]
    s_cbranch_vccnz L_hre_27
L_hre_ok_28:
    buffer_load_dwordx4 v[216:219], v17, s[4:7], s10 offen offset:1024 sc1
    v_mfma_f32_32x32x16_bf16 v[140:155], a[24:27], v[72:75], v[140:155]
    s_waitcnt vmcnt(19)
    v_max3_u32 v11, v76, v77, v78
    v_max_u32 v11, v11, v79
    v_cmp_eq_u32 vcc, -1, v11
    v_mfma_f32_32x32x16_bf16 v[156:171], a[28:31], v[72:75], v[156:171]
    s_cbranch_vccnz L_hre_29
L_hre_ok_30:
    buffer_load_dwordx4 v[220:223], v16, s[4:7], s10 offen offset:2048 sc1
    v_mfma_f32_32x32x16_bf16 v[124:139], a[36:39], v[76:79], v[124:139]
    s_waitcnt vmcnt(18)
    v_max3_u32 v11, v80, v81, v82
    v_max_u32 v11, v11, v83
    v_cmp_eq_u32 vcc, -1, v11
    v_mfma_f32_32x32x16_bf16 v[108:123], a[32:35], v[76:79], v[108:123]
    s_cbranch_vccnz L_hre_31
L_hre_ok_32:
    buffer_load_dwordx4 v[224:227], v17, s[4:7], s10 offen offset:2048 sc1
    v_mfma_f32_32x32x16_bf16 v[140:155], a[32:35], v[80:83], v[140:155]
    s_waitcnt vmcnt(17)
    v_max3_u32 v11, v84, v85, v86
    v_max_u32 v11, v11, v87
    v_cmp_eq_u32 vcc, -1, v11
    v_mfma_f32_32x32x16_bf16 v[156:171], a[36:39], v[80:83], v[156:171]
    s_cbranch_vccnz L_hre_33
L_hre_ok_34:
    buffer_load_dwordx4 v[228:231], v16, s[4:7], s10 offen offset:3072 sc1
    v_mfma_f32_32x32x16_bf16 v[124:139], a[44:47], v[84:87], v[124:139]
    s_waitcnt vmcnt(17)
    v_max3_u32 v11, v88, v89, v90
    v_max_u32 v11, v11, v91
    v_cmp_eq_u32 vcc, -1, v11
    v_mfma_f32_32x32x16_bf16 v[108:123], a[40:43], v[84:87], v[108:123]
    s_cbranch_vccnz L_hre_35
L_hre_ok_36:
    buffer_load_dwordx4 v[232:235], v17, s[4:7], s10 offen offset:3072 sc1
    v_mfma_f32_32x32x16_bf16 v[140:155], a[40:43], v[88:91], v[140:155]
    s_waitcnt vmcnt(17)
    v_max3_u32 v11, v92, v93, v94
    v_max_u32 v11, v11, v95
    v_cmp_eq_u32 vcc, -1, v11
    v_mfma_f32_32x32x16_bf16 v[156:171], a[44:47], v[88:91], v[156:171]
    s_cbranch_vccnz L_hre_37
L_hre_ok_38:
    s_add_u32 s10, s59, 12288
    buffer_load_dwordx4 v[236:239], v16, s[4:7], s10 offen offset:0 sc1
    v_mfma_f32_32x32x16_bf16 v[124:139], a[52:55], v[92:95], v[124:139]
    s_waitcnt vmcnt(17)
    v_max3_u32 v11, v96, v97, v98
    v_max_u32 v11, v11, v99
    v_cmp_eq_u32 vcc, -1, v11
    v_mfma_f32_32x32x16_bf16 v[108:123], a[48:51], v[92:95], v[108:123]
    s_cbranch_vccnz L_hre_39
L_hre_ok_40:
    buffer_load_dwordx4 v[240:243], v17, s[4:7], s10 offen offset:0 sc1
    v_mfma_f32_32x32x16_bf16 v[140:155], a[48:51], v[96:99], v[140:155]
    s_waitcnt vmcnt(17)
    v_max3_u32 v11, v100, v101, v102
    v_max_u32 v11, v11, v103
    v_cmp_eq_u32 vcc, -1, v11
    v_mfma_f32_32x32x16_bf16 v[156:171], a[52:55], v[96:99], v[156:171]
    s_cbranch_vccnz L_hre_41
L_hre_ok_42:
    buffer_load_dwordx4 v[244:247], v16, s[4:7], s10 offen offset:1024 sc1
    v_mfma_f32_32x32x16_bf16 v[124:139], a[60:63], v[100:103], v[124:139]
    s_waitcnt vmcnt(17)
    v_max3_u32 v11, v104, v105, v106
    v_max_u32 v11, v11, v107
    v_cmp_eq_u32 vcc, -1, v11
    v_mfma_f32_32x32x16_bf16 v[108:123], a[56:59], v[100:103], v[108:123]
    s_cbranch_vccnz L_hre_43
L_hre_ok_44:
    buffer_load_dwordx4 v[248:251], v17, s[4:7], s10 offen offset:1024 sc1
    v_mfma_f32_32x32x16_bf16 v[140:155], a[56:59], v[104:107], v[140:155]
    s_waitcnt vmcnt(17)
    v_max3_u32 v11, v204, v205, v206
    v_max_u32 v11, v11, v207
    v_cmp_eq_u32 vcc, -1, v11
    v_mfma_f32_32x32x16_bf16 v[156:171], a[60:63], v[104:107], v[156:171]
    s_cbranch_vccnz L_hre_45
L_hre_ok_46:
    buffer_load_dwordx4 v[252:255], v17, s[4:7], s10 offen offset:2048 sc1
    v_mfma_f32_32x32x16_bf16 v[124:139], a[68:71], v[204:207], v[124:139]
    s_waitcnt vmcnt(17)
    v_max3_u32 v11, v208, v209, v210
    v_max_u32 v11, v11, v211
    v_cmp_eq_u32 vcc, -1, v11
    v_mfma_f32_32x32x16_bf16 v[108:123], a[64:67], v[204:207], v[108:123]
    s_cbranch_vccnz L_hre_47
L_hre_ok_48:
    buffer_load_dwordx4 v[24:27], v17, s[4:7], s10 offen offset:3072 sc1
    v_mfma_f32_32x32x16_bf16 v[140:155], a[64:67], v[208:211], v[140:155]
    s_waitcnt vmcnt(11)
    v_max3_u32 v11, v212, v213, v214
    v_max_u32 v11, v11, v215
    v_cmp_eq_u32 vcc, -1, v11
    v_mfma_f32_32x32x16_bf16 v[156:171], a[68:71], v[208:211], v[156:171]
    s_cbranch_vccnz L_hre_49
L_hre_ok_50:
    s_add_u32 s10, s59, 16384
    buffer_load_dwordx4 v[188:191], v17, s[4:7], s10 offen offset:0 sc1
    v_mfma_f32_32x32x16_bf16 v[124:139], a[76:79], v[212:215], v[124:139]
    s_waitcnt vmcnt(11)
    v_max3_u32 v11, v216, v217, v218
    v_max_u32 v11, v11, v219
    v_cmp_eq_u32 vcc, -1, v11
    v_mfma_f32_32x32x16_bf16 v[108:123], a[72:75], v[212:215], v[108:123]
    s_cbranch_vccnz L_hre_51
L_hre_ok_52:
    buffer_load_dwordx4 v[192:195], v17, s[4:7], s10 offen offset:1024 sc1
    v_mfma_f32_32x32x16_bf16 v[140:155], a[72:75], v[216:219], v[140:155]
    s_waitcnt vmcnt(11)
    v_max3_u32 v11, v220, v221, v222
    v_max_u32 v11, v11, v223
    v_cmp_eq_u32 vcc, -1, v11
    v_mfma_f32_32x32x16_bf16 v[156:171], a[76:79], v[216:219], v[156:171]
    s_cbranch_vccnz L_hre_53
L_hre_ok_54:
    buffer_load_dwordx4 v[196:199], v17, s[4:7], s10 offen offset:2048 sc1
    v_mfma_f32_32x32x16_bf16 v[124:139], a[84:87], v[220:223], v[124:139]
    s_waitcnt vmcnt(11)
    v_max3_u32 v11, v224, v225, v226
    v_max_u32 v11, v11, v227
    v_cmp_eq_u32 vcc, -1, v11
    v_mfma_f32_32x32x16_bf16 v[108:123], a[80:83], v[220:223], v[108:123]
    s_cbranch_vccnz L_hre_55
L_hre_ok_56:
    buffer_load_dwordx4 v[44:47], v17, s[4:7], s10 offen offset:3072 sc1
    v_mfma_f32_32x32x16_bf16 v[140:155], a[80:83], v[224:227], v[140:155]
    s_waitcnt vmcnt(11)
    v_max3_u32 v11, v228, v229, v230
    v_max_u32 v11, v11, v231
    v_cmp_eq_u32 vcc, -1, v11
    v_mfma_f32_32x32x16_bf16 v[156:171], a[84:87], v[224:227], v[156:171]
    s_cbranch_vccnz L_hre_57
L_hre_ok_58:
    s_add_u32 s10, s59, 20480
    buffer_load_dwordx4 v[48:51], v17, s[4:7], s10 offen offset:0 sc1
    v_mfma_f32_32x32x16_bf16 v[124:139], a[92:95], v[228:231], v[124:139]
    s_waitcnt vmcnt(11)
    v_max3_u32 v11, v232, v233, v234
    v_max_u32 v11, v11, v235
    v_cmp_eq_u32 vcc, -1, v11
    v_mfma_f32_32x32x16_bf16 v[108:123], a[88:91], v[228:231], v[108:123]
    s_cbranch_vccnz L_hre_59
L_hre_ok_60:
    buffer_load_dwordx4 v[52:55], v17, s[4:7], s10 offen offset:1024 sc1
    v_mfma_f32_32x32x16_bf16 v[140:155], a[88:91], v[232:235], v[140:155]
    s_waitcnt vmcnt(11)
    v_max3_u32 v11, v236, v237, v238
    v_max_u32 v11, v11, v239
    v_cmp_eq_u32 vcc, -1, v11
    v_mfma_f32_32x32x16_bf16 v[156:171], a[92:95], v[232:235], v[156:171]
    s_cbranch_vccnz L_hre_61
L_hre_ok_62:
    buffer_load_dwordx4 v[56:59], v17, s[4:7], s10 offen offset:2048 sc1
    v_mfma_f32_32x32x16_bf16 v[124:139], a[100:103], v[236:239], v[124:139]
    s_waitcnt vmcnt(11)
    v_max3_u32 v11, v240, v241, v242
    v_max_u32 v11, v11, v243
    v_cmp_eq_u32 vcc, -1, v11
    v_mfma_f32_32x32x16_bf16 v[108:123], a[96:99], v[236:239], v[108:123]
    s_cbranch_vccnz L_hre_63
L_hre_ok_64:
    buffer_load_dwordx4 v[60:63], v17, s[4:7], s10 offen offset:3072 sc1
    v_mfma_f32_32x32x16_bf16 v[140:155], a[96:99], v[240:243], v[140:155]
    s_waitcnt vmcnt(11)
    v_max3_u32 v11, v244, v245, v246
    v_max_u32 v11, v11, v247
    v_cmp_eq_u32 vcc, -1, v11
    v_mfma_f32_32x32x16_bf16 v[156:171], a[100:103], v[240:243], v[156:171]
    s_cbranch_vccnz L_hre_65
L_hre_ok_66:
    s_add_u32 s10, s59, 24576
    buffer_load_dwordx4 v[64:67], v17, s[4:7], s10 offen offset:0 sc1
    v_mfma_f32_32x32x16_bf16 v[124:139], a[108:111], v[244:247], v[124:139]
    s_waitcnt vmcnt(11)
    v_max3_u32 v11, v248, v249, v250
    v_max_u32 v11, v11, v251
    v_cmp_eq_u32 vcc, -1, v11
    v_mfma_f32_32x32x16_bf16 v[108:123], a[104:107], v[244:247], v[108:123]
    s_cbranch_vccnz L_hre_67
L_hre_ok_68:
    buffer_load_dwordx4 v[68:71], v17, s[4:7], s10 offen offset:1024 sc1
    v_mfma_f32_32x32x16_bf16 v[140:155], a[104:107], v[248:251], v[140:155]
    s_waitcnt vmcnt(11)
    v_max3_u32 v11, v252, v253, v254
    v_max_u32 v11, v11, v255
    v_cmp_eq_u32 vcc, -1, v11
    v_mfma_f32_32x32x16_bf16 v[156:171], a[108:111], v[248:251], v[156:171]
    s_cbranch_vccnz L_hre_69
L_hre_ok_70:
    s_waitcnt lgkmcnt(0)
    buffer_load_dwordx4 v[72:75], v17, s[4:7], s10 offen offset:2048 sc1
    v_mfma_f32_32x32x16_bf16 v[140:155], a[112:115], v[252:255], v[140:155]
    s_waitcnt vmcnt(11)
    v_max3_u32 v11, v24, v25, v26
    v_max_u32 v11, v11, v27
    v_cmp_eq_u32 vcc, -1, v11
    v_mfma_f32_32x32x16_bf16 v[156:171], a[116:119], v[252:255], v[156:171]
    s_cbranch_vccnz L_hre_71
L_hre_ok_72:
    buffer_load_dwordx4 v[76:79], v17, s[4:7], s10 offen offset:3072 sc1
    v_mfma_f32_32x32x16_bf16 v[140:155], a[120:123], v[24:27], v[140:155]
    s_waitcnt vmcnt(11)
    v_max3_u32 v11, v188, v189, v190
    v_max_u32 v11, v11, v191
    v_cmp_eq_u32 vcc, -1, v11
    v_mfma_f32_32x32x16_bf16 v[156:171], a[124:127], v[24:27], v[156:171]
    s_cbranch_vccnz L_hre_73
L_hre_ok_74:
    s_add_u32 s10, s59, 12288
    buffer_load_dwordx4 v[80:83], v16, s[4:7], s10 offen offset:2048 sc1
    v_mfma_f32_32x32x16_bf16 v[140:155], a[128:131], v[188:191], v[140:155]
    s_waitcnt vmcnt(11)
    v_max3_u32 v11, v192, v193, v194
    v_max_u32 v11, v11, v195
    v_cmp_eq_u32 vcc, -1, v11
    v_mfma_f32_32x32x16_bf16 v[156:171], a[132:135], v[188:191], v[156:171]
    s_cbranch_vccnz L_hre_75
L_hre_ok_76:
    v_lshlrev_b32 v40, 16, v4
    v_and_b32 v41, 0xffff0000, v4
    buffer_load_dwordx4 v[84:87], v16, s[4:7], s10 offen offset:3072 sc1
    v_mfma_f32_32x32x16_bf16 v[140:155], a[136:139], v[192:195], v[140:155]
    s_waitcnt vmcnt(11)
    v_max3_u32 v11, v196, v197, v198
    v_max_u32 v11, v11, v199
    v_cmp_eq_u32 vcc, -1, v11
    v_mfma_f32_32x32x16_bf16 v[156:171], a[140:143], v[192:195], v[156:171]
    s_cbranch_vccnz L_hre_77
L_hre_ok_78:
    v_lshlrev_b32 v42, 16, v5
    v_and_b32 v43, 0xffff0000, v5
    s_add_u32 s10, s59, 16384
    buffer_load_dwordx4 v[88:91], v16, s[4:7], s10 offen offset:0 sc1
    v_mfma_f32_32x32x16_bf16 v[140:155], a[144:147], v[196:199], v[140:155]
    s_waitcnt vmcnt(11)
    v_max3_u32 v11, v44, v45, v46
    v_max_u32 v11, v11, v47
    v_cmp_eq_u32 vcc, -1, v11
    v_mfma_f32_32x32x16_bf16 v[156:171], a[148:151], v[196:199], v[156:171]
    s_cbranch_vccnz L_hre_79
L_hre_ok_80:
    v_lshlrev_b32 v36, 16, v6
    v_and_b32 v37, 0xffff0000, v6
    buffer_load_dwordx4 v[92:95], v16, s[4:7], s10 offen offset:1024 sc1
    v_mfma_f32_32x32x16_bf16 v[140:155], a[152:155], v[44:47], v[140:155]
    s_waitcnt vmcnt(11)
    v_max3_u32 v11, v48, v49, v50
    v_max_u32 v11, v11, v51
    v_cmp_eq_u32 vcc, -1, v11
    v_mfma_f32_32x32x16_bf16 v[156:171], a[156:159], v[44:47], v[156:171]
    s_cbranch_vccnz L_hre_81
L_hre_ok_82:
    v_lshlrev_b32 v38, 16, v7
    v_and_b32 v39, 0xffff0000, v7
    buffer_load_dwordx4 v[96:99], v16, s[4:7], s10 offen offset:2048 sc1
    v_mfma_f32_32x32x16_bf16 v[140:155], a[160:163], v[48:51], v[140:155]
    s_waitcnt vmcnt(11)
    v_max3_u32 v11, v52, v53, v54
    v_max_u32 v11, v11, v55
    v_cmp_eq_u32 vcc, -1, v11
    v_mfma_f32_32x32x16_bf16 v[156:171], a[164:167], v[48:51], v[156:171]
    s_cbranch_vccnz L_hre_83
L_hre_ok_84:
    v_lshlrev_b32 v32, 16, v200
    v_and_b32 v33, 0xffff0000, v200
    buffer_load_dwordx4 v[100:103], v16, s[4:7], s10 offen offset:3072 sc1
    v_mfma_f32_32x32x16_bf16 v[140:155], a[168:171], v[52:55], v[140:155]
    s_waitcnt vmcnt(11)
    v_max3_u32 v11, v56, v57, v58
    v_max_u32 v11, v11, v59
    v_cmp_eq_u32 vcc, -1, v11
    v_mfma_f32_32x32x16_bf16 v[156:171], a[172:175], v[52:55], v[156:171]
    s_cbranch_vccnz L_hre_85
L_hre_ok_86:
    v_lshlrev_b32 v34, 16, v201
    v_and_b32 v35, 0xffff0000, v201
    s_add_u32 s10, s59, 20480
    buffer_load_dwordx4 v[104:107], v16, s[4:7], s10 offen offset:0 sc1
    v_mfma_f32_32x32x16_bf16 v[140:155], a[176:179], v[56:59], v[140:155]
    s_waitcnt vmcnt(11)
    v_max3_u32 v11, v60, v61, v62
    v_max_u32 v11, v11, v63
    v_cmp_eq_u32 vcc, -1, v11
    v_mfma_f32_32x32x16_bf16 v[156:171], a[180:183], v[56:59], v[156:171]
    s_cbranch_vccnz L_hre_87
L_hre_ok_88:
    v_lshlrev_b32 v28, 16, v202
    v_and_b32 v29, 0xffff0000, v202
    buffer_load_dwordx4 v[204:207], v16, s[4:7], s10 offen offset:1024 sc1
    v_mfma_f32_32x32x16_bf16 v[140:155], a[184:187], v[60:63], v[140:155]
    s_waitcnt vmcnt(11)
    v_max3_u32 v11, v64, v65, v66
    v_max_u32 v11, v11, v67
    v_cmp_eq_u32 vcc, -1, v11
    v_mfma_f32_32x32x16_bf16 v[156:171], a[188:191], v[60:63], v[156:171]
    s_cbranch_vccnz L_hre_89
L_hre_ok_90:
    v_lshlrev_b32 v30, 16, v203
    v_and_b32 v31, 0xffff0000, v203
    buffer_load_dwordx4 v[208:211], v16, s[4:7], s10 offen offset:2048 sc1
    v_mfma_f32_32x32x16_bf16 v[140:155], a[192:195], v[64:67], v[140:155]
    s_waitcnt vmcnt(11)
    v_max3_u32 v11, v68, v69, v70
    v_max_u32 v11, v11, v71
    v_cmp_eq_u32 vcc, -1, v11
    v_mfma_f32_32x32x16_bf16 v[156:171], a[196:199], v[64:67], v[156:171]
    s_cbranch_vccnz L_hre_91
L_hre_ok_92:
    buffer_load_dwordx4 v[212:215], v16, s[4:7], s10 offen offset:3072 sc1
    v_mfma_f32_32x32x16_bf16 v[140:155], a[200:203], v[68:71], v[140:155]
    s_waitcnt vmcnt(11)
    v_max3_u32 v11, v72, v73, v74
    v_max_u32 v11, v11, v75
    v_cmp_eq_u32 vcc, -1, v11
    v_mfma_f32_32x32x16_bf16 v[156:171], a[204:207], v[68:71], v[156:171]
    s_cbranch_vccnz L_hre_93
L_hre_ok_94:
    s_add_u32 s10, s59, 24576
    buffer_load_dwordx4 v[216:219], v16, s[4:7], s10 offen offset:0 sc1
    v_mfma_f32_32x32x16_bf16 v[140:155], a[208:211], v[72:75], v[140:155]
    s_waitcnt vmcnt(11)
    v_max3_u32 v11, v76, v77, v78
    v_max_u32 v11, v11, v79
    v_cmp_eq_u32 vcc, -1, v11
    v_mfma_f32_32x32x16_bf16 v[156:171], a[212:215], v[72:75], v[156:171]
    s_cbranch_vccnz L_hre_95
L_hre_ok_96:
    buffer_load_dwordx4 v[220:223], v16, s[4:7], s10 offen offset:1024 sc1
    v_mfma_f32_32x32x16_bf16 v[140:155], a[216:219], v[76:79], v[140:155]
    s_waitcnt vmcnt(11)
    v_max3_u32 v11, v80, v81, v82
    v_max_u32 v11, v11, v83
    v_cmp_eq_u32 vcc, -1, v11
    v_mfma_f32_32x32x16_bf16 v[156:171], a[220:223], v[76:79], v[156:171]
    s_cbranch_vccnz L_hre_97
L_hre_ok_98:
    buffer_load_dwordx4 v[224:227], v16, s[4:7], s10 offen offset:2048 sc1
    v_mfma_f32_32x32x16_bf16 v[124:139], a[116:119], v[80:83], v[124:139]
    s_waitcnt vmcnt(11)
    v_max3_u32 v11, v84, v85, v86
    v_max_u32 v11, v11, v87
    v_cmp_eq_u32 vcc, -1, v11
    v_mfma_f32_32x32x16_bf16 v[108:123], a[112:115], v[80:83], v[108:123]
    s_cbranch_vccnz L_hre_99
L_hre_ok_100:
    buffer_load_dwordx4 v[228:231], v16, s[4:7], s10 offen offset:3072 sc1
    v_mfma_f32_32x32x16_bf16 v[124:139], a[124:127], v[84:87], v[124:139]
    s_waitcnt vmcnt(11)
    v_max3_u32 v11, v88, v89, v90
    v_max_u32 v11, v11, v91
    v_cmp_eq_u32 vcc, -1, v11
    v_mfma_f32_32x32x16_bf16 v[108:123], a[120:123], v[84:87], v[108:123]
    s_cbranch_vccnz L_hre_101
L_hre_ok_102:
    v_mfma_f32_32x32x16_bf16 v[124:139], a[132:135], v[88:91], v[124:139]
    s_waitcnt vmcnt(10)
    v_max3_u32 v11, v92, v93, v94
    v_max_u32 v11, v11, v95
    v_cmp_eq_u32 vcc, -1, v11
    v_mfma_f32_32x32x16_bf16 v[108:123], a[128:131], v[88:91], v[108:123]
    s_cbranch_vccnz L_hre_103
L_hre_ok_104:
    ds_write_b128 v20, v[140:143] offset:4096
    v_mfma_f32_32x32x16_bf16 v[124:139], a[140:143], v[92:95], v[124:139]
    s_waitcnt vmcnt(9)
    v_max3_u32 v11, v96, v97, v98
    v_max_u32 v11, v11, v99
    v_cmp_eq_u32 vcc, -1, v11
    v_mfma_f32_32x32x16_bf16 v[108:123], a[136:139], v[92:95], v[108:123]
    s_cbranch_vccnz L_hre_105
L_hre_ok_106:
    ds_write_b128 v20, v[144:147] offset:5120
    v_mfma_f32_32x32x16_bf16 v[124:139], a[148:151], v[96:99], v[124:139]
    s_waitcnt vmcnt(8)
    v_max3_u32 v11, v100, v101, v102
    v_max_u32 v11, v11, v103
    v_cmp_eq_u32 vcc, -1, v11
    v_mfma_f32_32x32x16_bf16 v[108:123], a[144:147], v[96:99], v[108:123]
    s_cbranch_vccnz L_hre_107
L_hre_ok_108:
    ds_write_b128 v20, v[148:151] offset:6144
    v_mfma_f32_32x32x16_bf16 v[124:139], a[156:159], v[100:103], v[124:139]
    s_waitcnt vmcnt(7)
    v_max3_u32 v11, v104, v105, v106
    v_max_u32 v11, v11, v107
    v_cmp_eq_u32 vcc, -1, v11
    v_mfma_f32_32x32x16_bf16 v[108:123], a[152:155], v[100:103], v[108:123]
    s_cbranch_vccnz L_hre_109
L_hre_ok_110:
    ds_write_b128 v20, v[152:155] offset:7168
    v_mfma_f32_32x32x16_bf16 v[124:139], a[164:167], v[104:107], v[124:139]
    s_waitcnt vmcnt(6)
    v_max3_u32 v11, v204, v205, v206
    v_max_u32 v11, v11, v207
    v_cmp_eq_u32 vcc, -1, v11
    v_mfma_f32_32x32x16_bf16 v[108:123], a[160:163], v[104:107], v[108:123]
    s_cbranch_vccnz L_hre_111
L_hre_ok_112:
    ds_write_b128 v20, v[156:159] offset:8192
    v_mfma_f32_32x32x16_bf16 v[124:139], a[172:175], v[204:207], v[124:139]
    s_waitcnt vmcnt(5)
    v_max3_u32 v11, v208, v209, v210
    v_max_u32 v11, v11, v211
    v_cmp_eq_u32 vcc, -1, v11
    v_mfma_f32_32x32x16_bf16 v[108:123], a[168:171], v[204:207], v[108:123]
    s_cbranch_vccnz L_hre_113
L_hre_ok_114:
    ds_write_b128 v20, v[160:163] offset:9216
    v_mfma_f32_32x32x16_bf16 v[124:139], a[180:183], v[208:211], v[124:139]
    s_waitcnt vmcnt(4)
    v_max3_u32 v11, v212, v213, v214
    v_max_u32 v11, v11, v215
    v_cmp_eq_u32 vcc, -1, v11
    v_mfma_f32_32x32x16_bf16 v[108:123], a[176:179], v[208:211], v[108:123]
    s_cbranch_vccnz L_hre_115
L_hre_ok_116:
    ds_write_b128 v20, v[164:167] offset:10240
    v_mfma_f32_32x32x16_bf16 v[124:139], a[188:191], v[212:215], v[124:139]
    s_waitcnt vmcnt(3)
    v_max3_u32 v11, v216, v217, v218
    v_max_u32 v11, v11, v219
    v_cmp_eq_u32 vcc, -1, v11
    v_mfma_f32_32x32x16_bf16 v[108:123], a[184:187], v[212:215], v[108:123]
    s_cbranch_vccnz L_hre_117
L_hre_ok_118:
    ds_write_b128 v20, v[168:171] offset:11264
    v_mfma_f32_32x32x16_bf16 v[124:139], a[196:199], v[216:219], v[124:139]
    s_waitcnt vmcnt(2)
    v_max3_u32 v11, v220, v221, v222
    v_max_u32 v11, v11, v223
    v_cmp_eq_u32 vcc, -1, v11
    v_mfma_f32_32x32x16_bf16 v[108:123], a[192:195], v[216:219], v[108:123]
    s_cbranch_vccnz L_hre_119
L_hre_ok_120:
    s_waitcnt vmcnt(1)
    v_max3_u32 v11, v224, v225, v226
    v_max_u32 v11, v11, v227
    v_cmp_eq_u32 vcc, -1, v11
    v_mfma_f32_32x32x16_bf16 v[124:139], a[204:207], v[220:223], v[124:139]
    s_cbranch_vccnz L_hre_121
L_hre_ok_122:
    s_waitcnt vmcnt(0)
    v_max3_u32 v11, v228, v229, v230
    v_max_u32 v11, v11, v231
    v_cmp_eq_u32 vcc, -1, v11
    v_mfma_f32_32x32x16_bf16 v[124:139], a[212:215], v[224:227], v[124:139]
    s_cbranch_vccnz L_hre_123
L_hre_ok_124:
    v_mfma_f32_32x32x16_bf16 v[124:139], a[220:223], v[228:231], v[124:139]
    v_mfma_f32_32x32x16_bf16 v[108:123], a[200:203], v[220:223], v[108:123]
    v_mfma_f32_32x32x16_bf16 v[108:123], a[208:211], v[224:227], v[108:123]
    s_nop 9
    ds_write_b128 v20, v[124:127] offset:0
    ds_write_b128 v20, v[128:131] offset:1024
    v_mfma_f32_32x32x16_bf16 v[108:123], a[216:219], v[228:231], v[108:123]
    ds_write_b128 v20, v[132:135] offset:2048
    ds_write_b128 v20, v[136:139] offset:3072
    s_waitcnt lgkmcnt(0)
    s_barrier
    ds_read_b128 v[60:63], v21 offset:0
    ds_read_b128 v[76:79], v22 offset:0
    ds_read_b128 v[92:95], v23 offset:0
    ds_read_b128 v[64:67], v21 offset:1024
    ds_read_b128 v[80:83], v22 offset:1024
    ds_read_b128 v[96:99], v23 offset:1024
    ds_read_b128 v[68:71], v21 offset:2048
    ds_read_b128 v[84:87], v22 offset:2048
    ds_read_b128 v[100:103], v23 offset:2048
    ds_read_b128 v[72:75], v21 offset:3072
    ds_read_b128 v[88:91], v22 offset:3072
    ds_read_b128 v[104:107], v23 offset:3072
    v_pk_add_f32 v[40:41], v[40:41], v[108:109]
    v_pk_add_f32 v[42:43], v[42:43], v[110:111]
    v_pk_add_f32 v[36:37], v[36:37], v[112:113]
    v_pk_add_f32 v[38:39], v[38:39], v[114:115]
    v_pk_add_f32 v[32:33], v[32:33], v[116:117]
    v_pk_add_f32 v[34:35], v[34:35], v[118:119]
    v_pk_add_f32 v[28:29], v[28:29], v[120:121]
    v_pk_add_f32 v[30:31], v[30:31], v[122:123]
    s_waitcnt lgkmcnt(11)
    v_pk_add_f32 v[40:41], v[40:41], v[60:61]
    v_pk_add_f32 v[42:43], v[42:43], v[62:63]
    s_waitcnt lgkmcnt(10)
    v_pk_add_f32 v[40:41], v[40:41], v[76:77]
    v_pk_add_f32 v[42:43], v[42:43], v[78:79]
    s_waitcnt lgkmcnt(9)
    v_pk_add_f32 v[40:41], v[40:41], v[92:93]
    v_pk_add_f32 v[42:43], v[42:43], v[94:95]
    v_cvt_pk_bf16_f32 v108, v40, v41
    v_cvt_pk_bf16_f32 v109, v42, v43
    s_waitcnt lgkmcnt(8)
    v_pk_add_f32 v[36:37], v[36:37], v[64:65]
    v_pk_add_f32 v[38:39], v[38:39], v[66:67]
    s_waitcnt lgkmcnt(7)
    v_pk_add_f32 v[36:37], v[36:37], v[80:81]
    v_pk_add_f32 v[38:39], v[38:39], v[82:83]
    s_waitcnt lgkmcnt(6)
    v_pk_add_f32 v[36:37], v[36:37], v[96:97]
    v_pk_add_f32 v[38:39], v[38:39], v[98:99]
    v_cvt_pk_bf16_f32 v110, v36, v37
    v_cvt_pk_bf16_f32 v111, v38, v39
    buffer_store_dwordx4 v[108:111], v18, s[32:35], s60 offen offset:0
    s_waitcnt lgkmcnt(5)
    v_pk_add_f32 v[32:33], v[32:33], v[68:69]
    v_pk_add_f32 v[34:35], v[34:35], v[70:71]
    s_waitcnt lgkmcnt(4)
    v_pk_add_f32 v[32:33], v[32:33], v[84:85]
    v_pk_add_f32 v[34:35], v[34:35], v[86:87]
    s_waitcnt lgkmcnt(3)
    v_pk_add_f32 v[32:33], v[32:33], v[100:101]
    v_pk_add_f32 v[34:35], v[34:35], v[102:103]
    v_cvt_pk_bf16_f32 v112, v32, v33
    v_cvt_pk_bf16_f32 v113, v34, v35
    s_waitcnt lgkmcnt(2)
    v_pk_add_f32 v[28:29], v[28:29], v[72:73]
    v_pk_add_f32 v[30:31], v[30:31], v[74:75]
    s_waitcnt lgkmcnt(1)
    v_pk_add_f32 v[28:29], v[28:29], v[88:89]
    v_pk_add_f32 v[30:31], v[30:31], v[90:91]
    s_waitcnt lgkmcnt(0)
    v_pk_add_f32 v[28:29], v[28:29], v[104:105]
    v_pk_add_f32 v[30:31], v[30:31], v[106:107]
    v_cvt_pk_bf16_f32 v114, v28, v29
    v_cvt_pk_bf16_f32 v115, v30, v31
    buffer_store_dwordx4 v[112:115], v18, s[32:35], s60 offen offset:16
L_fin:
L_end:
    s_endpgm
L_poll_2:
    s_cmp_eq_u32 s13, 0
    s_cbranch_scc1 L_pollok_3
    s_sub_u32 s13, s13, 1
    s_sleep 2
    buffer_load_dword v48, v63, s[4:7], s55 offen sc1
    s_waitcnt vmcnt(0)
    v_cmp_ne_u32 vcc, s54, v48
    s_nop 0
    s_cbranch_vccnz L_poll_2
    s_branch L_pollok_3
L_p3fail_5:
    s_cmp_eq_u32 s13, 0
    s_cbranch_scc1 L_p3ok_6
    s_sub_u32 s13, s13, 1
    s_barrier
    s_mov_b32 m0, s52
    s_nop 0
    buffer_load_dwordx4 v50, s[4:7], s36 offen sc1 lds
    s_add_u32 m0, s52, 4096
    s_nop 0
    buffer_load_dwordx4 v51, s[4:7], s36 offen sc1 lds
    s_waitcnt vmcnt(0)
    s_branch L_p3_4
L_poll_9:
    s_cmp_eq_u32 s13, 0
    s_cbranch_scc1 L_pollok_10
    s_sub_u32 s13, s13, 1
    s_sleep 2
    buffer_load_dword v11, v10, s[4:7], s56 offen sc1
    s_waitcnt vmcnt(0)
    v_cmp_ne_u32 vcc, s54, v11
    s_nop 0
    s_cbranch_vccnz L_poll_9
    s_branch L_pollok_10
L_hfail_11:
    s_cmp_eq_u32 s13, 0
    s_cbranch_scc1 L_hok_12
    s_sub_u32 s13, s13, 1
    s_mov_b32 s9, 15728640
    buffer_load_dword v11, v9, s[4:7], s9 offen sc1
    s_waitcnt vmcnt(0)
    v_cmp_ne_u32 vcc, s54, v11
    s_nop 0
    s_cbranch_vccnz L_hfail_11
    s_branch L_hok_12
L_hre_13:
    s_cmp_eq_u32 s13, 0
    s_cbranch_scc1 L_hre_ok_14
    s_sub_u32 s13, s13, 1
    s_add_u32 s3, s59, 0
    buffer_load_dwordx4 v[44:47], v16, s[4:7], s3 offen offset:0 sc1
    buffer_load_dwordx4 v[48:51], v17, s[4:7], s3 offen offset:0 sc1
    buffer_load_dwordx4 v[52:55], v16, s[4:7], s3 offen offset:1024 sc1
    buffer_load_dwordx4 v[56:59], v17, s[4:7], s3 offen offset:1024 sc1
    buffer_load_dwordx4 v[60:63], v16, s[4:7], s3 offen offset:2048 sc1
    buffer_load_dwordx4 v[64:67], v17, s[4:7], s3 offen offset:2048 sc1
    buffer_load_dwordx4 v[68:71], v16, s[4:7], s3 offen offset:3072 sc1
    buffer_load_dwordx4 v[72:75], v17, s[4:7], s3 offen offset:3072 sc1
    s_add_u32 s3, s59, 4096
    buffer_load_dwordx4 v[76:79], v16, s[4:7], s3 offen offset:0 sc1
    buffer_load_dwordx4 v[80:83], v17, s[4:7], s3 offen offset:0 sc1
    s_waitcnt vmcnt(0)
    v_max3_u32 v11, v44, v45, v46
    v_max_u32 v11, v11, v47
    v_cmp_eq_u32 vcc, -1, v11
    s_nop 0
    s_cbranch_vccnz L_hre_13
    s_branch L_hre_ok_14
L_hre_15:
    s_cmp_eq_u32 s13, 0
    s_cbranch_scc1 L_hre_ok_16
    s_sub_u32 s13, s13, 1
    s_add_u32 s3, s59, 0
    buffer_load_dwordx4 v[48:51], v17, s[4:7], s3 offen offset:0 sc1
    buffer_load_dwordx4 v[52:55], v16, s[4:7], s3 offen offset:1024 sc1
    buffer_load_dwordx4 v[56:59], v17, s[4:7], s3 offen offset:1024 sc1
    buffer_load_dwordx4 v[60:63], v16, s[4:7], s3 offen offset:2048 sc1
    buffer_load_dwordx4 v[64:67], v17, s[4:7], s3 offen offset:2048 sc1
    buffer_load_dwordx4 v[68:71], v16, s[4:7], s3 offen offset:3072 sc1
    buffer_load_dwordx4 v[72:75], v17, s[4:7], s3 offen offset:3072 sc1
    s_add_u32 s3, s59, 4096
    buffer_load_dwordx4 v[76:79], v16, s[4:7], s3 offen offset:0 sc1
    buffer_load_dwordx4 v[80:83], v17, s[4:7], s3 offen offset:0 sc1
    buffer_load_dwordx4 v[84:87], v16, s[4:7], s3 offen offset:1024 sc1
    s_waitcnt vmcnt(0)
    v_max3_u32 v11, v48, v49, v50
    v_max_u32 v11, v11, v51
    v_cmp_eq_u32 vcc, -1, v11
    s_nop 0
    s_cbranch_vccnz L_hre_15
    s_branch L_hre_ok_16
L_hre_17:
    s_cmp_eq_u32 s13, 0
    s_cbranch_scc1 L_hre_ok_18
    s_sub_u32 s13, s13, 1
    s_add_u32 s3, s59, 0
    buffer_load_dwordx4 v[52:55], v16, s[4:7], s3 offen offset:1024 sc1
    buffer_load_dwordx4 v[56:59], v17, s[4:7], s3 offen offset:1024 sc1
    buffer_load_dwordx4 v[60:63], v16, s[4:7], s3 offen offset:2048 sc1
    buffer_load_dwordx4 v[64:67], v17, s[4:7], s3 offen offset:2048 sc1
    buffer_load_dwordx4 v[68:71], v16, s[4:7], s3 offen offset:3072 sc1
    buffer_load_dwordx4 v[72:75], v17, s[4:7], s3 offen offset:3072 sc1
    s_add_u32 s3, s59, 4096
    buffer_load_dwordx4 v[76:79], v16, s[4:7], s3 offen offset:0 sc1
    buffer_load_dwordx4 v[80:83], v17, s[4:7], s3 offen offset:0 sc1
    buffer_load_dwordx4 v[84:87], v16, s[4:7], s3 offen offset:1024 sc1
    buffer_load_dwordx4 v[88:91], v17, s[4:7], s3 offen offset:1024 sc1
    s_waitcnt vmcnt(0)
    v_max3_u32 v11, v52, v53, v54
    v_max_u32 v11, v11, v55
    v_cmp_eq_u32 vcc, -1, v11
    s_nop 0
    s_cbranch_vccnz L_hre_17
    s_branch L_hre_ok_18
L_hre_19:
    s_cmp_eq_u32 s13, 0
    s_cbranch_scc1 L_hre_ok_20
    s_sub_u32 s13, s13, 1
    s_add_u32 s3, s59, 0
    buffer_load_dwordx4 v[56:59], v17, s[4:7], s3 offen offset:1024 sc1
    buffer_load_dwordx4 v[60:63], v16, s[4:7], s3 offen offset:2048 sc1
    buffer_load_dwordx4 v[64:67], v17, s[4:7], s3 offen offset:2048 sc1
    buffer_load_dwordx4 v[68:71], v16, s[4:7], s3 offen offset:3072 sc1
    buffer_load_dwordx4 v[72:75], v17, s[4:7], s3 offen offset:3072 sc1
    s_add_u32 s3, s59, 4096
    buffer_load_dwordx4 v[76:79], v16, s[4:7], s3 offen offset:0 sc1
    buffer_load_dwordx4 v[80:83], v17, s[4:7], s3 offen offset:0 sc1
    buffer_load_dwordx4 v[84:87], v16, s[4:7], s3 offen offset:1024 sc1
    buffer_load_dwordx4 v[88:91], v17, s[4:7], s3 offen offset:1024 sc1
    buffer_load_dwordx4 v[92:95], v16, s[4:7], s3 offen offset:2048 sc1
    s_waitcnt vmcnt(0)
    v_max3_u32 v11, v56, v57, v58
    v_max_u32 v11, v11, v59
    v_cmp_eq_u32 vcc, -1, v11
    s_nop 0
    s_cbranch_vccnz L_hre_19
    s_branch L_hre_ok_20
L_hre_21:
    s_cmp_eq_u32 s13, 0
    s_cbranch_scc1 L_hre_ok_22
    s_sub_u32 s13, s13, 1
    s_add_u32 s3, s59, 0
    buffer_load_dwordx4 v[60:63], v16, s[4:7], s3 offen offset:2048 sc1
    buffer_load_dwordx4 v[64:67], v17, s[4:7], s3 offen offset:2048 sc1
    buffer_load_dwordx4 v[68:71], v16, s[4:7], s3 offen offset:3072 sc1
    buffer_load_dwordx4 v[72:75], v17, s[4:7], s3 offen offset:3072 sc1
    s_add_u32 s3, s59, 4096
    buffer_load_dwordx4 v[76:79], v16, s[4:7], s3 offen offset:0 sc1
    buffer_load_dwordx4 v[80:83], v17, s[4:7], s3 offen offset:0 sc1
    buffer_load_dwordx4 v[84:87], v16, s[4:7], s3 offen offset:1024 sc1
    buffer_load_dwordx4 v[88:91], v17, s[4:7], s3 offen offset:1024 sc1
    buffer_load_dwordx4 v[92:95], v16, s[4:7], s3 offen offset:2048 sc1
    buffer_load_dwordx4 v[96:99], v17, s[4:7], s3 offen offset:2048 sc1
    s_waitcnt vmcnt(0)
    v_max3_u32 v11, v60, v61, v62
    v_max_u32 v11, v11, v63
    v_cmp_eq_u32 vcc, -1, v11
    s_nop 0
    s_cbranch_vccnz L_hre_21
    s_branch L_hre_ok_22
L_hre_23:
    s_cmp_eq_u32 s13, 0
    s_cbranch_scc1 L_hre_ok_24
    s_sub_u32 s13, s13, 1
    s_add_u32 s3, s59, 0
    buffer_load_dwordx4 v[64:67], v17, s[4:7], s3 offen offset:2048 sc1
    buffer_load_dwordx4 v[68:71], v16, s[4:7], s3 offen offset:3072 sc1
    buffer_load_dwordx4 v[72:75], v17, s[4:7], s3 offen offset:3072 sc1
    s_add_u32 s3, s59, 4096
    buffer_load_dwordx4 v[76:79], v16, s[4:7], s3 offen offset:0 sc1
    buffer_load_dwordx4 v[80:83], v17, s[4:7], s3 offen offset:0 sc1
    buffer_load_dwordx4 v[84:87], v16, s[4:7], s3 offen offset:1024 sc1
    buffer_load_dwordx4 v[88:91], v17, s[4:7], s3 offen offset:1024 sc1
    buffer_load_dwordx4 v[92:95], v16, s[4:7], s3 offen offset:2048 sc1
    buffer_load_dwordx4 v[96:99], v17, s[4:7], s3 offen offset:2048 sc1
    buffer_load_dwordx4 v[100:103], v16, s[4:7], s3 offen offset:3072 sc1
    s_waitcnt vmcnt(0)
    v_max3_u32 v11, v64, v65, v66
    v_max_u32 v11, v11, v67
    v_cmp_eq_u32 vcc, -1, v11
    s_nop 0
    s_cbranch_vccnz L_hre_23
    s_branch L_hre_ok_24
L_hre_25:
    s_cmp_eq_u32 s13, 0
    s_cbranch_scc1 L_hre_ok_26
    s_sub_u32 s13, s13, 1
    s_add_u32 s3, s59, 0
    buffer_load_dwordx4 v[68:71], v16, s[4:7], s3 offen offset:3072 sc1
    buffer_load_dwordx4 v[72:75], v17, s[4:7], s3 offen offset:3072 sc1
    s_add_u32 s3, s59, 4096
    buffer_load_dwordx4 v[76:79], v16, s[4:7], s3 offen offset:0 sc1
    buffer_load_dwordx4 v[80:83], v17, s[4:7], s3 offen offset:0 sc1
    buffer_load_dwordx4 v[84:87], v16, s[4:7], s3 offen offset:1024 sc1
    buffer_load_dwordx4 v[88:91], v17, s[4:7], s3 offen offset:1024 sc1
    buffer_load_dwordx4 v[92:95], v16, s[4:7], s3 offen offset:2048 sc1
    buffer_load_dwordx4 v[96:99], v17, s[4:7], s3 offen offset:2048 sc1
    buffer_load_dwordx4 v[100:103], v16, s[4:7], s3 offen offset:3072 sc1
    buffer_load_dwordx4 v[104:107], v17, s[4:7], s3 offen offset:3072 sc1
    s_waitcnt vmcnt(0)
    v_max3_u32 v11, v68, v69, v70
    v_max_u32 v11, v11, v71
    v_cmp_eq_u32 vcc, -1, v11
    s_nop 0
    s_cbranch_vccnz L_hre_25
    s_branch L_hre_ok_26
L_hre_27:
    s_cmp_eq_u32 s13, 0
    s_cbranch_scc1 L_hre_ok_28
    s_sub_u32 s13, s13, 1
    s_add_u32 s3, s59, 0
    buffer_load_dwordx4 v[72:75], v17, s[4:7], s3 offen offset:3072 sc1
    s_add_u32 s3, s59, 4096
    buffer_load_dwordx4 v[76:79], v16, s[4:7], s3 offen offset:0 sc1
    buffer_load_dwordx4 v[80:83], v17, s[4:7], s3 offen offset:0 sc1
    buffer_load_dwordx4 v[84:87], v16, s[4:7], s3 offen offset:1024 sc1
    buffer_load_dwordx4 v[88:91], v17, s[4:7], s3 offen offset:1024 sc1
    buffer_load_dwordx4 v[92:95], v16, s[4:7], s3 offen offset:2048 sc1
    buffer_load_dwordx4 v[96:99], v17, s[4:7], s3 offen offset:2048 sc1
    buffer_load_dwordx4 v[100:103], v16, s[4:7], s3 offen offset:3072 sc1
    buffer_load_dwordx4 v[104:107], v17, s[4:7], s3 offen offset:3072 sc1
    s_add_u32 s3, s59, 8192
    buffer_load_dwordx4 v[204:207], v16, s[4:7], s3 offen offset:0 sc1
    s_waitcnt vmcnt(0)
    v_max3_u32 v11, v72, v73, v74
    v_max_u32 v11, v11, v75
    v_cmp_eq_u32 vcc, -1, v11
    s_nop 0
    s_cbranch_vccnz L_hre_27
    s_branch L_hre_ok_28
L_hre_29:
    s_cmp_eq_u32 s13, 0
    s_cbranch_scc1 L_hre_ok_30
    s_sub_u32 s13, s13, 1
    s_add_u32 s3, s59, 4096
    buffer_load_dwordx4 v[76:79], v16, s[4:7], s3 offen offset:0 sc1
    buffer_load_dwordx4 v[80:83], v17, s[4:7], s3 offen offset:0 sc1
    buffer_load_dwordx4 v[84:87], v16, s[4:7], s3 offen offset:1024 sc1
    buffer_load_dwordx4 v[88:91], v17, s[4:7], s3 offen offset:1024 sc1
    buffer_load_dwordx4 v[92:95], v16, s[4:7], s3 offen offset:2048 sc1
    buffer_load_dwordx4 v[96:99], v17, s[4:7], s3 offen offset:2048 sc1
    buffer_load_dwordx4 v[100:103], v16, s[4:7], s3 offen offset:3072 sc1
    buffer_load_dwordx4 v[104:107], v17, s[4:7], s3 offen offset:3072 sc1
    s_add_u32 s3, s59, 8192
    buffer_load_dwordx4 v[204:207], v16, s[4:7], s3 offen offset:0 sc1
    buffer_load_dwordx4 v[208:211], v17, s[4:7], s3 offen offset:0 sc1
    s_waitcnt vmcnt(0)
    v_max3_u32 v11, v76, v77, v78
    v_max_u32 v11, v11, v79
    v_cmp_eq_u32 vcc, -1, v11
    s_nop 0
    s_cbranch_vccnz L_hre_29
    s_branch L_hre_ok_30
L_hre_31:
    s_cmp_eq_u32 s13, 0
    s_cbranch_scc1 L_hre_ok_32
    s_sub_u32 s13, s13, 1
    s_add_u32 s3, s59, 4096
    buffer_load_dwordx4 v[80:83], v17, s[4:7], s3 offen offset:0 sc1
    buffer_load_dwordx4 v[84:87], v16, s[4:7], s3 offen offset:1024 sc1
    buffer_load_dwordx4 v[88:91], v17, s[4:7], s3 offen offset:1024 sc1
    buffer_load_dwordx4 v[92:95], v16, s[4:7], s3 offen offset:2048 sc1
    buffer_load_dwordx4 v[96:99], v17, s[4:7], s3 offen offset:2048 sc1
    buffer_load_dwordx4 v[100:103], v16, s[4:7], s3 offen offset:3072 sc1
    buffer_load_dwordx4 v[104:107], v17, s[4:7], s3 offen offset:3072 sc1
    s_add_u32 s3, s59, 8192
    buffer_load_dwordx4 v[204:207], v16, s[4:7], s3 offen offset:0 sc1
    buffer_load_dwordx4 v[208:211], v17, s[4:7], s3 offen offset:0 sc1
    buffer_load_dwordx4 v[212:215], v16, s[4:7], s3 offen offset:1024 sc1
    s_waitcnt vmcnt(0)
    v_max3_u32 v11, v80, v81, v82
    v_max_u32 v11, v11, v83
    v_cmp_eq_u32 vcc, -1, v11
    s_nop 0
    s_cbranch_vccnz L_hre_31
    s_branch L_hre_ok_32
L_hre_33:
    s_cmp_eq_u32 s13, 0
    s_cbranch_scc1 L_hre_ok_34
    s_sub_u32 s13, s13, 1
    s_add_u32 s3, s59, 4096
    buffer_load_dwordx4 v[84:87], v16, s[4:7], s3 offen offset:1024 sc1
    buffer_load_dwordx4 v[88:91], v17, s[4:7], s3 offen offset:1024 sc1
    buffer_load_dwordx4 v[92:95], v16, s[4:7], s3 offen offset:2048 sc1
    buffer_load_dwordx4 v[96:99], v17, s[4:7], s3 offen offset:2048 sc1
    buffer_load_dwordx4 v[100:103], v16, s[4:7], s3 offen offset:3072 sc1
    buffer_load_dwordx4 v[104:107], v17, s[4:7], s3 offen offset:3072 sc1
    s_add_u32 s3, s59, 8192
    buffer_load_dwordx4 v[204:207], v16, s[4:7], s3 offen offset:0 sc1
    buffer_load_dwordx4 v[208:211], v17, s[4:7], s3 offen offset:0 sc1
    buffer_load_dwordx4 v[212:215], v16, s[4:7], s3 offen offset:1024 sc1
    buffer_load_dwordx4 v[216:219], v17, s[4:7], s3 offen offset:1024 sc1
    s_waitcnt vmcnt(0)
    v_max3_u32 v11, v84, v85, v86
    v_max_u32 v11, v11, v87
    v_cmp_eq_u32 vcc, -1, v11
    s_nop 0
    s_cbranch_vccnz L_hre_33
    s_branch L_hre_ok_34
L_hre_35:
    s_cmp_eq_u32 s13, 0
    s_cbranch_scc1 L_hre_ok_36
    s_sub_u32 s13, s13, 1
    s_add_u32 s3, s59, 4096
    buffer_load_dwordx4 v[88:91], v17, s[4:7], s3 offen offset:1024 sc1
    buffer_load_dwordx4 v[92:95], v16, s[4:7], s3 offen offset:2048 sc1
    buffer_load_dwordx4 v[96:99], v17, s[4:7], s3 offen offset:2048 sc1
    buffer_load_dwordx4 v[100:103], v16, s[4:7], s3 offen offset:3072 sc1
    buffer_load_dwordx4 v[104:107], v17, s[4:7], s3 offen offset:3072 sc1
    s_add_u32 s3, s59, 8192
    buffer_load_dwordx4 v[204:207], v16, s[4:7], s3 offen offset:0 sc1
    buffer_load_dwordx4 v[208:211], v17, s[4:7], s3 offen offset:0 sc1
    buffer_load_dwordx4 v[212:215], v16, s[4:7], s3 offen offset:1024 sc1
    buffer_load_dwordx4 v[216:219], v17, s[4:7], s3 offen offset:1024 sc1
    buffer_load_dwordx4 v[220:223], v16, s[4:7], s3 offen offset:2048 sc1
    s_waitcnt vmcnt(0)
    v_max3_u32 v11, v88, v89, v90
    v_max_u32 v11, v11, v91
    v_cmp_eq_u32 vcc, -1, v11
    s_nop 0
    s_cbranch_vccnz L_hre_35
    s_branch L_hre_ok_36
L_hre_37:
    s_cmp_eq_u32 s13, 0
    s_cbranch_scc1 L_hre_ok_38
    s_sub_u32 s13, s13, 1
    s_add_u32 s3, s59, 4096
    buffer_load_dwordx4 v[92:95], v16, s[4:7], s3 offen offset:2048 sc1
    buffer_load_dwordx4 v[96:99], v17, s[4:7], s3 offen offset:2048 sc1
    buffer_load_dwordx4 v[100:103], v16, s[4:7], s3 offen offset:3072 sc1
    buffer_load_dwordx4 v[104:107], v17, s[4:7], s3 offen offset:3072 sc1
    s_add_u32 s3, s59, 8192
    buffer_load_dwordx4 v[204:207], v16, s[4:7], s3 offen offset:0 sc1
    buffer_load_dwordx4 v[208:211], v17, s[4:7], s3 offen offset:0 sc1
    buffer_load_dwordx4 v[212:215], v16, s[4:7], s3 offen offset:1024 sc1
    buffer_load_dwordx4 v[216:219], v17, s[4:7], s3 offen offset:1024 sc1
    buffer_load_dwordx4 v[220:223], v16, s[4:7], s3 offen offset:2048 sc1
    buffer_load_dwordx4 v[224:227], v17, s[4:7], s3 offen offset:2048 sc1
    s_waitcnt vmcnt(0)
    v_max3_u32 v11, v92, v93, v94
    v_max_u32 v11, v11, v95
    v_cmp_eq_u32 vcc, -1, v11
    s_nop 0
    s_cbranch_vccnz L_hre_37
    s_branch L_hre_ok_38
L_hre_39:
    s_cmp_eq_u32 s13, 0
    s_cbranch_scc1 L_hre_ok_40
    s_sub_u32 s13, s13, 1
    s_add_u32 s3, s59, 4096
    buffer_load_dwordx4 v[96:99], v17, s[4:7], s3 offen offset:2048 sc1
    buffer_load_dwordx4 v[100:103], v16, s[4:7], s3 offen offset:3072 sc1
    buffer_load_dwordx4 v[104:107], v17, s[4:7], s3 offen offset:3072 sc1
    s_add_u32 s3, s59, 8192
    buffer_load_dwordx4 v[204:207], v16, s[4:7], s3 offen offset:0 sc1
    buffer_load_dwordx4 v[208:211], v17, s[4:7], s3 offen offset:0 sc1
    buffer_load_dwordx4 v[212:215], v16, s[4:7], s3 offen offset:1024 sc1
    buffer_load_dwordx4 v[216:219], v17, s[4:7], s3 offen offset:1024 sc1
    buffer_load_dwordx4 v[220:223], v16, s[4:7], s3 offen offset:2048 sc1
    buffer_load_dwordx4 v[224:227], v17, s[4:7], s3 offen offset:2048 sc1
    buffer_load_dwordx4 v[228:231], v16, s[4:7], s3 offen offset:3072 sc1
    s_waitcnt vmcnt(0)
    v_max3_u32 v11, v96, v97, v98
    v_max_u32 v11, v11, v99
    v_cmp_eq_u32 vcc, -1, v11
    s_nop 0
    s_cbranch_vccnz L_hre_39
    s_branch L_hre_ok_40
L_hre_41:
    s_cmp_eq_u32 s13, 0
    s_cbranch_scc1 L_hre_ok_42
    s_sub_u32 s13, s13, 1
    s_add_u32 s3, s59, 4096
    buffer_load_dwordx4 v[100:103], v16, s[4:7], s3 offen offset:3072 sc1
    buffer_load_dwordx4 v[104:107], v17, s[4:7], s3 offen offset:3072 sc1
    s_add_u32 s3, s59, 8192
    buffer_load_dwordx4 v[204:207], v16, s[4:7], s3 offen offset:0 sc1
    buffer_load_dwordx4 v[208:211], v17, s[4:7], s3 offen offset:0 sc1
    buffer_load_dwordx4 v[212:215], v16, s[4:7], s3 offen offset:1024 sc1
    buffer_load_dwordx4 v[216:219], v17, s[4:7], s3 offen offset:1024 sc1
    buffer_load_dwordx4 v[220:223], v16, s[4:7], s3 offen offset:2048 sc1
    buffer_load_dwordx4 v[224:227], v17, s[4:7], s3 offen offset:2048 sc1
    buffer_load_dwordx4 v[228:231], v16, s[4:7], s3 offen offset:3072 sc1
    buffer_load_dwordx4 v[232:235], v17, s[4:7], s3 offen offset:3072 sc1
    s_waitcnt vmcnt(0)
    v_max3_u32 v11, v100, v101, v102
    v_max_u32 v11, v11, v103
    v_cmp_eq_u32 vcc, -1, v11
    s_nop 0
    s_cbranch_vccnz L_hre_41
    s_branch L_hre_ok_42
L_hre_43:
    s_cmp_eq_u32 s13, 0
    s_cbranch_scc1 L_hre_ok_44
    s_sub_u32 s13, s13, 1
    s_add_u32 s3, s59, 4096
    buffer_load_dwordx4 v[104:107], v17, s[4:7], s3 offen offset:3072 sc1
    s_add_u32 s3, s59, 8192
    buffer_load_dwordx4 v[204:207], v16, s[4:7], s3 offen offset:0 sc1
    buffer_load_dwordx4 v[208:211], v17, s[4:7], s3 offen offset:0 sc1
    buffer_load_dwordx4 v[212:215], v16, s[4:7], s3 offen offset:1024 sc1
    buffer_load_dwordx4 v[216:219], v17, s[4:7], s3 offen offset:1024 sc1
    buffer_load_dwordx4 v[220:223], v16, s[4:7], s3 offen offset:2048 sc1
    buffer_load_dwordx4 v[224:227], v17, s[4:7], s3 offen offset:2048 sc1
    buffer_load_dwordx4 v[228:231], v16, s[4:7], s3 offen offset:3072 sc1
    buffer_load_dwordx4 v[232:235], v17, s[4:7], s3 offen offset:3072 sc1
    s_add_u32 s3, s59, 12288
    buffer_load_dwordx4 v[236:239], v16, s[4:7], s3 offen offset:0 sc1
    s_waitcnt vmcnt(0)
    v_max3_u32 v11, v104, v105, v106
    v_max_u32 v11, v11, v107
    v_cmp_eq_u32 vcc, -1, v11
    s_nop 0
    s_cbranch_vccnz L_hre_43
    s_branch L_hre_ok_44
L_hre_45:
    s_cmp_eq_u32 s13, 0
    s_cbranch_scc1 L_hre_ok_46
    s_sub_u32 s13, s13, 1
    s_add_u32 s3, s59, 8192
    buffer_load_dwordx4 v[204:207], v16, s[4:7], s3 offen offset:0 sc1
    buffer_load_dwordx4 v[208:211], v17, s[4:7], s3 offen offset:0 sc1
    buffer_load_dwordx4 v[212:215], v16, s[4:7], s3 offen offset:1024 sc1
    buffer_load_dwordx4 v[216:219], v17, s[4:7], s3 offen offset:1024 sc1
    buffer_load_dwordx4 v[220:223], v16, s[4:7], s3 offen offset:2048 sc1
    buffer_load_dwordx4 v[224:227], v17, s[4:7], s3 offen offset:2048 sc1
    buffer_load_dwordx4 v[228:231], v16, s[4:7], s3 offen offset:3072 sc1
    buffer_load_dwordx4 v[232:235], v17, s[4:7], s3 offen offset:3072 sc1
    s_add_u32 s3, s59, 12288
    buffer_load_dwordx4 v[236:239], v16, s[4:7], s3 offen offset:0 sc1
    buffer_load_dwordx4 v[240:243], v17, s[4:7], s3 offen offset:0 sc1
    s_waitcnt vmcnt(0)
    v_max3_u32 v11, v204, v205, v206
    v_max_u32 v11, v11, v207
    v_cmp_eq_u32 vcc, -1, v11
    s_nop 0
    s_cbranch_vccnz L_hre_45
    s_branch L_hre_ok_46
L_hre_47:
    s_cmp_eq_u32 s13, 0
    s_cbranch_scc1 L_hre_ok_48
    s_sub_u32 s13, s13, 1
    s_add_u32 s3, s59, 8192
    buffer_load_dwordx4 v[208:211], v17, s[4:7], s3 offen offset:0 sc1
    buffer_load_dwordx4 v[212:215], v16, s[4:7], s3 offen offset:1024 sc1
    buffer_load_dwordx4 v[216:219], v17, s[4:7], s3 offen offset:1024 sc1
    buffer_load_dwordx4 v[220:223], v16, s[4:7], s3 offen offset:2048 sc1
    buffer_load_dwordx4 v[224:227], v17, s[4:7], s3 offen offset:2048 sc1
    buffer_load_dwordx4 v[228:231], v16, s[4:7], s3 offen offset:3072 sc1
    buffer_load_dwordx4 v[232:235], v17, s[4:7], s3 offen offset:3072 sc1
    s_add_u32 s3, s59, 12288
    buffer_load_dwordx4 v[236:239], v16, s[4:7], s3 offen offset:0 sc1
    buffer_load_dwordx4 v[240:243], v17, s[4:7], s3 offen offset:0 sc1
    buffer_load_dwordx4 v[244:247], v16, s[4:7], s3 offen offset:1024 sc1
    s_waitcnt vmcnt(0)
    v_max3_u32 v11, v208, v209, v210
    v_max_u32 v11, v11, v211
    v_cmp_eq_u32 vcc, -1, v11
    s_nop 0
    s_cbranch_vccnz L_hre_47
    s_branch L_hre_ok_48
L_hre_49:
    s_cmp_eq_u32 s13, 0
    s_cbranch_scc1 L_hre_ok_50
    s_sub_u32 s13, s13, 1
    s_add_u32 s3, s59, 8192
    buffer_load_dwordx4 v[212:215], v16, s[4:7], s3 offen offset:1024 sc1
    buffer_load_dwordx4 v[216:219], v17, s[4:7], s3 offen offset:1024 sc1
    buffer_load_dwordx4 v[220:223], v16, s[4:7], s3 offen offset:2048 sc1
    buffer_load_dwordx4 v[224:227], v17, s[4:7], s3 offen offset:2048 sc1
    buffer_load_dwordx4 v[228:231], v16, s[4:7], s3 offen offset:3072 sc1
    buffer_load_dwordx4 v[232:235], v17, s[4:7], s3 offen offset:3072 sc1
    s_add_u32 s3, s59, 12288
    buffer_load_dwordx4 v[236:239], v16, s[4:7], s3 offen offset:0 sc1
    buffer_load_dwordx4 v[240:243], v17, s[4:7], s3 offen offset:0 sc1
    buffer_load_dwordx4 v[244:247], v16, s[4:7], s3 offen offset:1024 sc1
    buffer_load_dwordx4 v[248:251], v17, s[4:7], s3 offen offset:1024 sc1
    s_waitcnt vmcnt(0)
    v_max3_u32 v11, v212, v213, v214
    v_max_u32 v11, v11, v215
    v_cmp_eq_u32 vcc, -1, v11
    s_nop 0
    s_cbranch_vccnz L_hre_49
    s_branch L_hre_ok_50
L_hre_51:
    s_cmp_eq_u32 s13, 0
    s_cbranch_scc1 L_hre_ok_52
    s_sub_u32 s13, s13, 1
    s_add_u32 s3, s59, 8192
    buffer_load_dwordx4 v[216:219], v17, s[4:7], s3 offen offset:1024 sc1
    buffer_load_dwordx4 v[220:223], v16, s[4:7], s3 offen offset:2048 sc1
    buffer_load_dwordx4 v[224:227], v17, s[4:7], s3 offen offset:2048 sc1
    buffer_load_dwordx4 v[228:231], v16, s[4:7], s3 offen offset:3072 sc1
    buffer_load_dwordx4 v[232:235], v17, s[4:7], s3 offen offset:3072 sc1
    s_add_u32 s3, s59, 12288
    buffer_load_dwordx4 v[236:239], v16, s[4:7], s3 offen offset:0 sc1
    buffer_load_dwordx4 v[240:243], v17, s[4:7], s3 offen offset:0 sc1
    buffer_load_dwordx4 v[244:247], v16, s[4:7], s3 offen offset:1024 sc1
    buffer_load_dwordx4 v[248:251], v17, s[4:7], s3 offen offset:1024 sc1
    buffer_load_dwordx4 v[252:255], v17, s[4:7], s3 offen offset:2048 sc1
    s_waitcnt vmcnt(0)
    v_max3_u32 v11, v216, v217, v218
    v_max_u32 v11, v11, v219
    v_cmp_eq_u32 vcc, -1, v11
    s_nop 0
    s_cbranch_vccnz L_hre_51
    s_branch L_hre_ok_52
L_hre_53:
    s_cmp_eq_u32 s13, 0
    s_cbranch_scc1 L_hre_ok_54
    s_sub_u32 s13, s13, 1
    s_add_u32 s3, s59, 8192
    buffer_load_dwordx4 v[220:223], v16, s[4:7], s3 offen offset:2048 sc1
    buffer_load_dwordx4 v[224:227], v17, s[4:7], s3 offen offset:2048 sc1
    buffer_load_dwordx4 v[228:231], v16, s[4:7], s3 offen offset:3072 sc1
    buffer_load_dwordx4 v[232:235], v17, s[4:7], s3 offen offset:3072 sc1
    s_add_u32 s3, s59, 12288
    buffer_load_dwordx4 v[236:239], v16, s[4:7], s3 offen offset:0 sc1
    buffer_load_dwordx4 v[240:243], v17, s[4:7], s3 offen offset:0 sc1
    buffer_load_dwordx4 v[244:247], v16, s[4:7], s3 offen offset:1024 sc1
    buffer_load_dwordx4 v[248:251], v17, s[4:7], s3 offen offset:1024 sc1
    buffer_load_dwordx4 v[252:255], v17, s[4:7], s3 offen offset:2048 sc1
    buffer_load_dwordx4 v[24:27], v17, s[4:7], s3 offen offset:3072 sc1
    s_waitcnt vmcnt(0)
    v_max3_u32 v11, v220, v221, v222
    v_max_u32 v11, v11, v223
    v_cmp_eq_u32 vcc, -1, v11
    s_nop 0
    s_cbranch_vccnz L_hre_53
    s_branch L_hre_ok_54
L_hre_55:
    s_cmp_eq_u32 s13, 0
    s_cbranch_scc1 L_hre_ok_56
    s_sub_u32 s13, s13, 1
    s_add_u32 s3, s59, 8192
    buffer_load_dwordx4 v[224:227], v17, s[4:7], s3 offen offset:2048 sc1
    buffer_load_dwordx4 v[228:231], v16, s[4:7], s3 offen offset:3072 sc1
    buffer_load_dwordx4 v[232:235], v17, s[4:7], s3 offen offset:3072 sc1
    s_add_u32 s3, s59, 12288
    buffer_load_dwordx4 v[236:239], v16, s[4:7], s3 offen offset:0 sc1
    buffer_load_dwordx4 v[240:243], v17, s[4:7], s3 offen offset:0 sc1
    buffer_load_dwordx4 v[244:247], v16, s[4:7], s3 offen offset:1024 sc1
    buffer_load_dwordx4 v[248:251], v17, s[4:7], s3 offen offset:1024 sc1
    buffer_load_dwordx4 v[252:255], v17, s[4:7], s3 offen offset:2048 sc1
    buffer_load_dwordx4 v[24:27], v17, s[4:7], s3 offen offset:3072 sc1
    s_add_u32 s3, s59, 16384
    buffer_load_dwordx4 v[188:191], v17, s[4:7], s3 offen offset:0 sc1
    s_waitcnt vmcnt(0)
    v_max3_u32 v11, v224, v225, v226
    v_max_u32 v11, v11, v227
    v_cmp_eq_u32 vcc, -1, v11
    s_nop 0
    s_cbranch_vccnz L_hre_55
    s_branch L_hre_ok_56
L_hre_57:
    s_cmp_eq_u32 s13, 0
    s_cbranch_scc1 L_hre_ok_58
    s_sub_u32 s13, s13, 1
    s_add_u32 s3, s59, 8192
    buffer_load_dwordx4 v[228:231], v16, s[4:7], s3 offen offset:3072 sc1
    buffer_load_dwordx4 v[232:235], v17, s[4:7], s3 offen offset:3072 sc1
    s_add_u32 s3, s59, 12288
    buffer_load_dwordx4 v[236:239], v16, s[4:7], s3 offen offset:0 sc1
    buffer_load_dwordx4 v[240:243], v17, s[4:7], s3 offen offset:0 sc1
    buffer_load_dwordx4 v[244:247], v16, s[4:7], s3 offen offset:1024 sc1
    buffer_load_dwordx4 v[248:251], v17, s[4:7], s3 offen offset:1024 sc1
    buffer_load_dwordx4 v[252:255], v17, s[4:7], s3 offen offset:2048 sc1
    buffer_load_dwordx4 v[24:27], v17, s[4:7], s3 offen offset:3072 sc1
    s_add_u32 s3, s59, 16384
    buffer_load_dwordx4 v[188:191], v17, s[4:7], s3 offen offset:0 sc1
    buffer_load_dwordx4 v[192:195], v17, s[4:7], s3 offen offset:1024 sc1
    s_waitcnt vmcnt(0)
    v_max3_u32 v11, v228, v229, v230
    v_max_u32 v11, v11, v231
    v_cmp_eq_u32 vcc, -1, v11
    s_nop 0
    s_cbranch_vccnz L_hre_57
    s_branch L_hre_ok_58
L_hre_59:
    s_cmp_eq_u32 s13, 0
    s_cbranch_scc1 L_hre_ok_60
    s_sub_u32 s13, s13, 1
    s_add_u32 s3, s59, 8192
    buffer_load_dwordx4 v[232:235], v17, s[4:7], s3 offen offset:3072 sc1
    s_add_u32 s3, s59, 12288
    buffer_load_dwordx4 v[236:239], v16, s[4:7], s3 offen offset:0 sc1
    buffer_load_dwordx4 v[240:243], v17, s[4:7], s3 offen offset:0 sc1
    buffer_load_dwordx4 v[244:247], v16, s[4:7], s3 offen offset:1024 sc1
    buffer_load_dwordx4 v[248:251], v17, s[4:7], s3 offen offset:1024 sc1
    buffer_load_dwordx4 v[252:255], v17, s[4:7], s3 offen offset:2048 sc1
    buffer_load_dwordx4 v[24:27], v17, s[4:7], s3 offen offset:3072 sc1
    s_add_u32 s3, s59, 16384
    buffer_load_dwordx4 v[188:191], v17, s[4:7], s3 offen offset:0 sc1
    buffer_load_dwordx4 v[192:195], v17, s[4:7], s3 offen offset:1024 sc1
    buffer_load_dwordx4 v[196:199], v17, s[4:7], s3 offen offset:2048 sc1
    s_waitcnt vmcnt(0)
    v_max3_u32 v11, v232, v233, v234
    v_max_u32 v11, v11, v235
    v_cmp_eq_u32 vcc, -1, v11
    s_nop 0
    s_cbranch_vccnz L_hre_59
    s_branch L_hre_ok_60
L_hre_61:
    s_cmp_eq_u32 s13, 0
    s_cbranch_scc1 L_hre_ok_62
    s_sub_u32 s13, s13, 1
    s_add_u32 s3, s59, 12288
    buffer_load_dwordx4 v[236:239], v16, s[4:7], s3 offen offset:0 sc1
    buffer_load_dwordx4 v[240:243], v17, s[4:7], s3 offen offset:0 sc1
    buffer_load_dwordx4 v[244:247], v16, s[4:7], s3 offen offset:1024 sc1
    buffer_load_dwordx4 v[248:251], v17, s[4:7], s3 offen offset:1024 sc1
    buffer_load_dwordx4 v[252:255], v17, s[4:7], s3 offen offset:2048 sc1
    buffer_load_dwordx4 v[24:27], v17, s[4:7], s3 offen offset:3072 sc1
    s_add_u32 s3, s59, 16384
    buffer_load_dwordx4 v[188:191], v17, s[4:7], s3 offen offset:0 sc1
    buffer_load_dwordx4 v[192:195], v17, s[4:7], s3 offen offset:1024 sc1
    buffer_load_dwordx4 v[196:199], v17, s[4:7], s3 offen offset:2048 sc1
    buffer_load_dwordx4 v[44:47], v17, s[4:7], s3 offen offset:3072 sc1
    s_waitcnt vmcnt(0)
    v_max3_u32 v11, v236, v237, v238
    v_max_u32 v11, v11, v239
    v_cmp_eq_u32 vcc, -1, v11
    s_nop 0
    s_cbranch_vccnz L_hre_61
    s_branch L_hre_ok_62
L_hre_63:
    s_cmp_eq_u32 s13, 0
    s_cbranch_scc1 L_hre_ok_64
    s_sub_u32 s13, s13, 1
    s_add_u32 s3, s59, 12288
    buffer_load_dwordx4 v[240:243], v17, s[4:7], s3 offen offset:0 sc1
    buffer_load_dwordx4 v[244:247], v16, s[4:7], s3 offen offset:1024 sc1
    buffer_load_dwordx4 v[248:251], v17, s[4:7], s3 offen offset:1024 sc1
    buffer_load_dwordx4 v[252:255], v17, s[4:7], s3 offen offset:2048 sc1
    buffer_load_dwordx4 v[24:27], v17, s[4:7], s3 offen offset:3072 sc1
    s_add_u32 s3, s59, 16384
    buffer_load_dwordx4 v[188:191], v17, s[4:7], s3 offen offset:0 sc1
    buffer_load_dwordx4 v[192:195], v17, s[4:7], s3 offen offset:1024 sc1
    buffer_load_dwordx4 v[196:199], v17, s[4:7], s3 offen offset:2048 sc1
    buffer_load_dwordx4 v[44:47], v17, s[4:7], s3 offen offset:3072 sc1
    s_add_u32 s3, s59, 20480
    buffer_load_dwordx4 v[48:51], v17, s[4:7], s3 offen offset:0 sc1
    s_waitcnt vmcnt(0)
    v_max3_u32 v11, v240, v241, v242
    v_max_u32 v11, v11, v243
    v_cmp_eq_u32 vcc, -1, v11
    s_nop 0
    s_cbranch_vccnz L_hre_63
    s_branch L_hre_ok_64
L_hre_65:
    s_cmp_eq_u32 s13, 0
    s_cbranch_scc1 L_hre_ok_66
    s_sub_u32 s13, s13, 1
    s_add_u32 s3, s59, 12288
    buffer_load_dwordx4 v[244:247], v16, s[4:7], s3 offen offset:1024 sc1
    buffer_load_dwordx4 v[248:251], v17, s[4:7], s3 offen offset:1024 sc1
    buffer_load_dwordx4 v[252:255], v17, s[4:7], s3 offen offset:2048 sc1
    buffer_load_dwordx4 v[24:27], v17, s[4:7], s3 offen offset:3072 sc1
    s_add_u32 s3, s59, 16384
    buffer_load_dwordx4 v[188:191], v17, s[4:7], s3 offen offset:0 sc1
    buffer_load_dwordx4 v[192:195], v17, s[4:7], s3 offen offset:1024 sc1
    buffer_load_dwordx4 v[196:199], v17, s[4:7], s3 offen offset:2048 sc1
    buffer_load_dwordx4 v[44:47], v17, s[4:7], s3 offen offset:3072 sc1
    s_add_u32 s3, s59, 20480
    buffer_load_dwordx4 v[48:51], v17, s[4:7], s3 offen offset:0 sc1
    buffer_load_dwordx4 v[52:55], v17, s[4:7], s3 offen offset:1024 sc1
    s_waitcnt vmcnt(0)
    v_max3_u32 v11, v244, v245, v246
    v_max_u32 v11, v11, v247
    v_cmp_eq_u32 vcc, -1, v11
    s_nop 0
    s_cbranch_vccnz L_hre_65
    s_branch L_hre_ok_66
L_hre_67:
    s_cmp_eq_u32 s13, 0
    s_cbranch_scc1 L_hre_ok_68
    s_sub_u32 s13, s13, 1
    s_add_u32 s3, s59, 12288
    buffer_load_dwordx4 v[248:251], v17, s[4:7], s3 offen offset:1024 sc1
    buffer_load_dwordx4 v[252:255], v17, s[4:7], s3 offen offset:2048 sc1
    buffer_load_dwordx4 v[24:27], v17, s[4:7], s3 offen offset:3072 sc1
    s_add_u32 s3, s59, 16384
    buffer_load_dwordx4 v[188:191], v17, s[4:7], s3 offen offset:0 sc1
    buffer_load_dwordx4 v[192:195], v17, s[4:7], s3 offen offset:1024 sc1
    buffer_load_dwordx4 v[196:199], v17, s[4:7], s3 offen offset:2048 sc1
    buffer_load_dwordx4 v[44:47], v17, s[4:7], s3 offen offset:3072 sc1
    s_add_u32 s3, s59, 20480
    buffer_load_dwordx4 v[48:51], v17, s[4:7], s3 offen offset:0 sc1
    buffer_load_dwordx4 v[52:55], v17, s[4:7], s3 offen offset:1024 sc1
    buffer_load_dwordx4 v[56:59], v17, s[4:7], s3 offen offset:2048 sc1
    s_waitcnt vmcnt(0)
    v_max3_u32 v11, v248, v249, v250
    v_max_u32 v11, v11, v251
    v_cmp_eq_u32 vcc, -1, v11
    s_nop 0
    s_cbranch_vccnz L_hre_67
    s_branch L_hre_ok_68
L_hre_69:
    s_cmp_eq_u32 s13, 0
    s_cbranch_scc1 L_hre_ok_70
    s_sub_u32 s13, s13, 1
    s_add_u32 s3, s59, 12288
    buffer_load_dwordx4 v[252:255], v17, s[4:7], s3 offen offset:2048 sc1
    buffer_load_dwordx4 v[24:27], v17, s[4:7], s3 offen offset:3072 sc1
    s_add_u32 s3, s59, 16384
    buffer_load_dwordx4 v[188:191], v17, s[4:7], s3 offen offset:0 sc1
    buffer_load_dwordx4 v[192:195], v17, s[4:7], s3 offen offset:1024 sc1
    buffer_load_dwordx4 v[196:199], v17, s[4:7], s3 offen offset:2048 sc1
    buffer_load_dwordx4 v[44:47], v17, s[4:7], s3 offen offset:3072 sc1
    s_add_u32 s3, s59, 20480
    buffer_load_dwordx4 v[48:51], v17, s[4:7], s3 offen offset:0 sc1
    buffer_load_dwordx4 v[52:55], v17, s[4:7], s3 offen offset:1024 sc1
    buffer_load_dwordx4 v[56:59], v17, s[4:7], s3 offen offset:2048 sc1
    buffer_load_dwordx4 v[60:63], v17, s[4:7], s3 offen offset:3072 sc1
    s_waitcnt vmcnt(0)
    v_max3_u32 v11, v252, v253, v254
    v_max_u32 v11, v11, v255
    v_cmp_eq_u32 vcc, -1, v11
    s_nop 0
    s_cbranch_vccnz L_hre_69
    s_branch L_hre_ok_70
L_hre_71:
    s_cmp_eq_u32 s13, 0
    s_cbranch_scc1 L_hre_ok_72
    s_sub_u32 s13, s13, 1
    s_add_u32 s3, s59, 12288
    buffer_load_dwordx4 v[24:27], v17, s[4:7], s3 offen offset:3072 sc1
    s_add_u32 s3, s59, 16384
    buffer_load_dwordx4 v[188:191], v17, s[4:7], s3 offen offset:0 sc1
    buffer_load_dwordx4 v[192:195], v17, s[4:7], s3 offen offset:1024 sc1
    buffer_load_dwordx4 v[196:199], v17, s[4:7], s3 offen offset:2048 sc1
    buffer_load_dwordx4 v[44:47], v17, s[4:7], s3 offen offset:3072 sc1
    s_add_u32 s3, s59, 20480
    buffer_load_dwordx4 v[48:51], v17, s[4:7], s3 offen offset:0 sc1
    buffer_load_dwordx4 v[52:55], v17, s[4:7], s3 offen offset:1024 sc1
    buffer_load_dwordx4 v[56:59], v17, s[4:7], s3 offen offset:2048 sc1
    buffer_load_dwordx4 v[60:63], v17, s[4:7], s3 offen offset:3072 sc1
    s_add_u32 s3, s59, 24576
    buffer_load_dwordx4 v[64:67], v17, s[4:7], s3 offen offset:0 sc1
    s_waitcnt vmcnt(0)
    v_max3_u32 v11, v24, v25, v26
    v_max_u32 v11, v11, v27
    v_cmp_eq_u32 vcc, -1, v11
    s_nop 0
    s_cbranch_vccnz L_hre_71
    s_branch L_hre_ok_72
L_hre_73:
    s_cmp_eq_u32 s13, 0
    s_cbranch_scc1 L_hre_ok_74
    s_sub_u32 s13, s13, 1
    s_add_u32 s3, s59, 16384
    buffer_load_dwordx4 v[188:191], v17, s[4:7], s3 offen offset:0 sc1
    buffer_load_dwordx4 v[192:195], v17, s[4:7], s3 offen offset:1024 sc1
    buffer_load_dwordx4 v[196:199], v17, s[4:7], s3 offen offset:2048 sc1
    buffer_load_dwordx4 v[44:47], v17, s[4:7], s3 offen offset:3072 sc1
    s_add_u32 s3, s59, 20480
    buffer_load_dwordx4 v[48:51], v17, s[4:7], s3 offen offset:0 sc1
    buffer_load_dwordx4 v[52:55], v17, s[4:7], s3 offen offset:1024 sc1
    buffer_load_dwordx4 v[56:59], v17, s[4:7], s3 offen offset:2048 sc1
    buffer_load_dwordx4 v[60:63], v17, s[4:7], s3 offen offset:3072 sc1
    s_add_u32 s3, s59, 24576
    buffer_load_dwordx4 v[64:67], v17, s[4:7], s3 offen offset:0 sc1
    buffer_load_dwordx4 v[68:71], v17, s[4:7], s3 offen offset:1024 sc1
    s_waitcnt vmcnt(0)
    v_max3_u32 v11, v188, v189, v190
    v_max_u32 v11, v11, v191
    v_cmp_eq_u32 vcc, -1, v11
    s_nop 0
    s_cbranch_vccnz L_hre_73
    s_branch L_hre_ok_74
L_hre_75:
    s_cmp_eq_u32 s13, 0
    s_cbranch_scc1 L_hre_ok_76
    s_sub_u32 s13, s13, 1
    s_add_u32 s3, s59, 16384
    buffer_load_dwordx4 v[192:195], v17, s[4:7], s3 offen offset:1024 sc1
    buffer_load_dwordx4 v[196:199], v17, s[4:7], s3 offen offset:2048 sc1
    buffer_load_dwordx4 v[44:47], v17, s[4:7], s3 offen offset:3072 sc1
    s_add_u32 s3, s59, 20480
    buffer_load_dwordx4 v[48:51], v17, s[4:7], s3 offen offset:0 sc1
    buffer_load_dwordx4 v[52:55], v17, s[4:7], s3 offen offset:1024 sc1
    buffer_load_dwordx4 v[56:59], v17, s[4:7], s3 offen offset:2048 sc1
    buffer_load_dwordx4 v[60:63], v17, s[4:7], s3 offen offset:3072 sc1
    s_add_u32 s3, s59, 24576
    buffer_load_dwordx4 v[64:67], v17, s[4:7], s3 offen offset:0 sc1
    buffer_load_dwordx4 v[68:71], v17, s[4:7], s3 offen offset:1024 sc1
    buffer_load_dwordx4 v[72:75], v17, s[4:7], s3 offen offset:2048 sc1
    s_waitcnt vmcnt(0)
    v_max3_u32 v11, v192, v193, v194
    v_max_u32 v11, v11, v195
    v_cmp_eq_u32 vcc, -1, v11
    s_nop 0
    s_cbranch_vccnz L_hre_75
    s_branch L_hre_ok_76
L_hre_77:
    s_cmp_eq_u32 s13, 0
    s_cbranch_scc1 L_hre_ok_78
    s_sub_u32 s13, s13, 1
    s_add_u32 s3, s59, 16384
    buffer_load_dwordx4 v[196:199], v17, s[4:7], s3 offen offset:2048 sc1
    buffer_load_dwordx4 v[44:47], v17, s[4:7], s3 offen offset:3072 sc1
    s_add_u32 s3, s59, 20480
    buffer_load_dwordx4 v[48:51], v17, s[4:7], s3 offen offset:0 sc1
    buffer_load_dwordx4 v[52:55], v17, s[4:7], s3 offen offset:1024 sc1
    buffer_load_dwordx4 v[56:59], v17, s[4:7], s3 offen offset:2048 sc1
    buffer_load_dwordx4 v[60:63], v17, s[4:7], s3 offen offset:3072 sc1
    s_add_u32 s3, s59, 24576
    buffer_load_dwordx4 v[64:67], v17, s[4:7], s3 offen offset:0 sc1
    buffer_load_dwordx4 v[68:71], v17, s[4:7], s3 offen offset:1024 sc1
    buffer_load_dwordx4 v[72:75], v17, s[4:7], s3 offen offset:2048 sc1
    buffer_load_dwordx4 v[76:79], v17, s[4:7], s3 offen offset:3072 sc1
    s_waitcnt vmcnt(0)
    v_max3_u32 v11, v196, v197, v198
    v_max_u32 v11, v11, v199
    v_cmp_eq_u32 vcc, -1, v11
    s_nop 0
    s_cbranch_vccnz L_hre_77
    s_branch L_hre_ok_78
L_hre_79:
    s_cmp_eq_u32 s13, 0
    s_cbranch_scc1 L_hre_ok_80
    s_sub_u32 s13, s13, 1
    s_add_u32 s3, s59, 16384
    buffer_load_dwordx4 v[44:47], v17, s[4:7], s3 offen offset:3072 sc1
    s_add_u32 s3, s59, 20480
    buffer_load_dwordx4 v[48:51], v17, s[4:7], s3 offen offset:0 sc1
    buffer_load_dwordx4 v[52:55], v17, s[4:7], s3 offen offset:1024 sc1
    buffer_load_dwordx4 v[56:59], v17, s[4:7], s3 offen offset:2048 sc1
    buffer_load_dwordx4 v[60:63], v17, s[4:7], s3 offen offset:3072 sc1
    s_add_u32 s3, s59, 24576
    buffer_load_dwordx4 v[64:67], v17, s[4:7], s3 offen offset:0 sc1
    buffer_load_dwordx4 v[68:71], v17, s[4:7], s3 offen offset:1024 sc1
    buffer_load_dwordx4 v[72:75], v17, s[4:7], s3 offen offset:2048 sc1
    buffer_load_dwordx4 v[76:79], v17, s[4:7], s3 offen offset:3072 sc1
    s_add_u32 s3, s59, 12288
    buffer_load_dwordx4 v[80:83], v16, s[4:7], s3 offen offset:2048 sc1
    s_waitcnt vmcnt(0)
    v_max3_u32 v11, v44, v45, v46
    v_max_u32 v11, v11, v47
    v_cmp_eq_u32 vcc, -1, v11
    s_nop 0
    s_cbranch_vccnz L_hre_79
    s_branch L_hre_ok_80
L_hre_81:
    s_cmp_eq_u32 s13, 0
    s_cbranch_scc1 L_hre_ok_82
    s_sub_u32 s13, s13, 1
    s_add_u32 s3, s59, 20480
    buffer_load_dwordx4 v[48:51], v17, s[4:7], s3 offen offset:0 sc1
    buffer_load_dwordx4 v[52:55], v17, s[4:7], s3 offen offset:1024 sc1
    buffer_load_dwordx4 v[56:59], v17, s[4:7], s3 offen offset:2048 sc1
    buffer_load_dwordx4 v[60:63], v17, s[4:7], s3 offen offset:3072 sc1
    s_add_u32 s3, s59, 24576
    buffer_load_dwordx4 v[64:67], v17, s[4:7], s3 offen offset:0 sc1
    buffer_load_dwordx4 v[68:71], v17, s[4:7], s3 offen offset:1024 sc1
    buffer_load_dwordx4 v[72:75], v17, s[4:7], s3 offen offset:2048 sc1
    buffer_load_dwordx4 v[76:79], v17, s[4:7], s3 offen offset:3072 sc1
    s_add_u32 s3, s59, 12288
    buffer_load_dwordx4 v[80:83], v16, s[4:7], s3 offen offset:2048 sc1
    buffer_load_dwordx4 v[84:87], v16, s[4:7], s3 offen offset:3072 sc1
    s_waitcnt vmcnt(0)
    v_max3_u32 v11, v48, v49, v50
    v_max_u32 v11, v11, v51
    v_cmp_eq_u32 vcc, -1, v11
    s_nop 0
    s_cbranch_vccnz L_hre_81
    s_branch L_hre_ok_82
L_hre_83:
    s_cmp_eq_u32 s13, 0
    s_cbranch_scc1 L_hre_ok_84
    s_sub_u32 s13, s13, 1
    s_add_u32 s3, s59, 20480
    buffer_load_dwordx4 v[52:55], v17, s[4:7], s3 offen offset:1024 sc1
    buffer_load_dwordx4 v[56:59], v17, s[4:7], s3 offen offset:2048 sc1
    buffer_load_dwordx4 v[60:63], v17, s[4:7], s3 offen offset:3072 sc1
    s_add_u32 s3, s59, 24576
    buffer_load_dwordx4 v[64:67], v17, s[4:7], s3 offen offset:0 sc1
    buffer_load_dwordx4 v[68:71], v17, s[4:7], s3 offen offset:1024 sc1
    buffer_load_dwordx4 v[72:75], v17, s[4:7], s3 offen offset:2048 sc1
    buffer_load_dwordx4 v[76:79], v17, s[4:7], s3 offen offset:3072 sc1
    s_add_u32 s3, s59, 12288
    buffer_load_dwordx4 v[80:83], v16, s[4:7], s3 offen offset:2048 sc1
    buffer_load_dwordx4 v[84:87], v16, s[4:7], s3 offen offset:3072 sc1
    s_add_u32 s3, s59, 16384
    buffer_load_dwordx4 v[88:91], v16, s[4:7], s3 offen offset:0 sc1
    s_waitcnt vmcnt(0)
    v_max3_u32 v11, v52, v53, v54
    v_max_u32 v11, v11, v55
    v_cmp_eq_u32 vcc, -1, v11
    s_nop 0
    s_cbranch_vccnz L_hre_83
    s_branch L_hre_ok_84
L_hre_85:
    s_cmp_eq_u32 s13, 0
    s_cbranch_scc1 L_hre_ok_86
    s_sub_u32 s13, s13, 1
    s_add_u32 s3, s59, 20480
    buffer_load_dwordx4 v[56:59], v17, s[4:7], s3 offen offset:2048 sc1
    buffer_load_dwordx4 v[60:63], v17, s[4:7], s3 offen offset:3072 sc1
    s_add_u32 s3, s59, 24576
    buffer_load_dwordx4 v[64:67], v17, s[4:7], s3 offen offset:0 sc1
    buffer_load_dwordx4 v[68:71], v17, s[4:7], s3 offen offset:1024 sc1
    buffer_load_dwordx4 v[72:75], v17, s[4:7], s3 offen offset:2048 sc1
    buffer_load_dwordx4 v[76:79], v17, s[4:7], s3 offen offset:3072 sc1
    s_add_u32 s3, s59, 12288
    buffer_load_dwordx4 v[80:83], v16, s[4:7], s3 offen offset:2048 sc1
    buffer_load_dwordx4 v[84:87], v16, s[4:7], s3 offen offset:3072 sc1
    s_add_u32 s3, s59, 16384
    buffer_load_dwordx4 v[88:91], v16, s[4:7], s3 offen offset:0 sc1
    buffer_load_dwordx4 v[92:95], v16, s[4:7], s3 offen offset:1024 sc1
    s_waitcnt vmcnt(0)
    v_max3_u32 v11, v56, v57, v58
    v_max_u32 v11, v11, v59
    v_cmp_eq_u32 vcc, -1, v11
    s_nop 0
    s_cbranch_vccnz L_hre_85
    s_branch L_hre_ok_86
L_hre_87:
    s_cmp_eq_u32 s13, 0
    s_cbranch_scc1 L_hre_ok_88
    s_sub_u32 s13, s13, 1
    s_add_u32 s3, s59, 20480
    buffer_load_dwordx4 v[60:63], v17, s[4:7], s3 offen offset:3072 sc1
    s_add_u32 s3, s59, 24576
    buffer_load_dwordx4 v[64:67], v17, s[4:7], s3 offen offset:0 sc1
    buffer_load_dwordx4 v[68:71], v17, s[4:7], s3 offen offset:1024 sc1
    buffer_load_dwordx4 v[72:75], v17, s[4:7], s3 offen offset:2048 sc1
    buffer_load_dwordx4 v[76:79], v17, s[4:7], s3 offen offset:3072 sc1
    s_add_u32 s3, s59, 12288
    buffer_load_dwordx4 v[80:83], v16, s[4:7], s3 offen offset:2048 sc1
    buffer_load_dwordx4 v[84:87], v16, s[4:7], s3 offen offset:3072 sc1
    s_add_u32 s3, s59, 16384
    buffer_load_dwordx4 v[88:91], v16, s[4:7], s3 offen offset:0 sc1
    buffer_load_dwordx4 v[92:95], v16, s[4:7], s3 offen offset:1024 sc1
    buffer_load_dwordx4 v[96:99], v16, s[4:7], s3 offen offset:2048 sc1
    s_waitcnt vmcnt(0)
    v_max3_u32 v11, v60, v61, v62
    v_max_u32 v11, v11, v63
    v_cmp_eq_u32 vcc, -1, v11
    s_nop 0
    s_cbranch_vccnz L_hre_87
    s_branch L_hre_ok_88
L_hre_89:
    s_cmp_eq_u32 s13, 0
    s_cbranch_scc1 L_hre_ok_90
    s_sub_u32 s13, s13, 1
    s_add_u32 s3, s59, 24576
    buffer_load_dwordx4 v[64:67], v17, s[4:7], s3 offen offset:0 sc1
    buffer_load_dwordx4 v[68:71], v17, s[4:7], s3 offen offset:1024 sc1
    buffer_load_dwordx4 v[72:75], v17, s[4:7], s3 offen offset:2048 sc1
    buffer_load_dwordx4 v[76:79], v17, s[4:7], s3 offen offset:3072 sc1
    s_add_u32 s3, s59, 12288
    buffer_load_dwordx4 v[80:83], v16, s[4:7], s3 offen offset:2048 sc1
    buffer_load_dwordx4 v[84:87], v16, s[4:7], s3 offen offset:3072 sc1
    s_add_u32 s3, s59, 16384
    buffer_load_dwordx4 v[88:91], v16, s[4:7], s3 offen offset:0 sc1
    buffer_load_dwordx4 v[92:95], v16, s[4:7], s3 offen offset:1024 sc1
    buffer_load_dwordx4 v[96:99], v16, s[4:7], s3 offen offset:2048 sc1
    buffer_load_dwordx4 v[100:103], v16, s[4:7], s3 offen offset:3072 sc1
    s_waitcnt vmcnt(0)
    v_max3_u32 v11, v64, v65, v66
    v_max_u32 v11, v11, v67
    v_cmp_eq_u32 vcc, -1, v11
    s_nop 0
    s_cbranch_vccnz L_hre_89
    s_branch L_hre_ok_90
L_hre_91:
    s_cmp_eq_u32 s13, 0
    s_cbranch_scc1 L_hre_ok_92
    s_sub_u32 s13, s13, 1
    s_add_u32 s3, s59, 24576
    buffer_load_dwordx4 v[68:71], v17, s[4:7], s3 offen offset:1024 sc1
    buffer_load_dwordx4 v[72:75], v17, s[4:7], s3 offen offset:2048 sc1
    buffer_load_dwordx4 v[76:79], v17, s[4:7], s3 offen offset:3072 sc1
    s_add_u32 s3, s59, 12288
    buffer_load_dwordx4 v[80:83], v16, s[4:7], s3 offen offset:2048 sc1
    buffer_load_dwordx4 v[84:87], v16, s[4:7], s3 offen offset:3072 sc1
    s_add_u32 s3, s59, 16384
    buffer_load_dwordx4 v[88:91], v16, s[4:7], s3 offen offset:0 sc1
    buffer_load_dwordx4 v[92:95], v16, s[4:7], s3 offen offset:1024 sc1
    buffer_load_dwordx4 v[96:99], v16, s[4:7], s3 offen offset:2048 sc1
    buffer_load_dwordx4 v[100:103], v16, s[4:7], s3 offen offset:3072 sc1
    s_add_u32 s3, s59, 20480
    buffer_load_dwordx4 v[104:107], v16, s[4:7], s3 offen offset:0 sc1
    s_waitcnt vmcnt(0)
    v_max3_u32 v11, v68, v69, v70
    v_max_u32 v11, v11, v71
    v_cmp_eq_u32 vcc, -1, v11
    s_nop 0
    s_cbranch_vccnz L_hre_91
    s_branch L_hre_ok_92
L_hre_93:
    s_cmp_eq_u32 s13, 0
    s_cbranch_scc1 L_hre_ok_94
    s_sub_u32 s13, s13, 1
    s_add_u32 s3, s59, 24576
    buffer_load_dwordx4 v[72:75], v17, s[4:7], s3 offen offset:2048 sc1
    buffer_load_dwordx4 v[76:79], v17, s[4:7], s3 offen offset:3072 sc1
    s_add_u32 s3, s59, 12288
    buffer_load_dwordx4 v[80:83], v16, s[4:7], s3 offen offset:2048 sc1
    buffer_load_dwordx4 v[84:87], v16, s[4:7], s3 offen offset:3072 sc1
    s_add_u32 s3, s59, 16384
    buffer_load_dwordx4 v[88:91], v16, s[4:7], s3 offen offset:0 sc1
    buffer_load_dwordx4 v[92:95], v16, s[4:7], s3 offen offset:1024 sc1
    buffer_load_dwordx4 v[96:99], v16, s[4:7], s3 offen offset:2048 sc1
    buffer_load_dwordx4 v[100:103], v16, s[4:7], s3 offen offset:3072 sc1
    s_add_u32 s3, s59, 20480
    buffer_load_dwordx4 v[104:107], v16, s[4:7], s3 offen offset:0 sc1
    buffer_load_dwordx4 v[204:207], v16, s[4:7], s3 offen offset:1024 sc1
    s_waitcnt vmcnt(0)
    v_max3_u32 v11, v72, v73, v74
    v_max_u32 v11, v11, v75
    v_cmp_eq_u32 vcc, -1, v11
    s_nop 0
    s_cbranch_vccnz L_hre_93
    s_branch L_hre_ok_94
L_hre_95:
    s_cmp_eq_u32 s13, 0
    s_cbranch_scc1 L_hre_ok_96
    s_sub_u32 s13, s13, 1
    s_add_u32 s3, s59, 24576
    buffer_load_dwordx4 v[76:79], v17, s[4:7], s3 offen offset:3072 sc1
    s_add_u32 s3, s59, 12288
    buffer_load_dwordx4 v[80:83], v16, s[4:7], s3 offen offset:2048 sc1
    buffer_load_dwordx4 v[84:87], v16, s[4:7], s3 offen offset:3072 sc1
    s_add_u32 s3, s59, 16384
    buffer_load_dwordx4 v[88:91], v16, s[4:7], s3 offen offset:0 sc1
    buffer_load_dwordx4 v[92:95], v16, s[4:7], s3 offen offset:1024 sc1
    buffer_load_dwordx4 v[96:99], v16, s[4:7], s3 offen offset:2048 sc1
    buffer_load_dwordx4 v[100:103], v16, s[4:7], s3 offen offset:3072 sc1
    s_add_u32 s3, s59, 20480
    buffer_load_dwordx4 v[104:107], v16, s[4:7], s3 offen offset:0 sc1
    buffer_load_dwordx4 v[204:207], v16, s[4:7], s3 offen offset:1024 sc1
    buffer_load_dwordx4 v[208:211], v16, s[4:7], s3 offen offset:2048 sc1
    s_waitcnt vmcnt(0)
    v_max3_u32 v11, v76, v77, v78
    v_max_u32 v11, v11, v79
    v_cmp_eq_u32 vcc, -1, v11
    s_nop 0
    s_cbranch_vccnz L_hre_95
    s_branch L_hre_ok_96
L_hre_97:
    s_cmp_eq_u32 s13, 0
    s_cbranch_scc1 L_hre_ok_98
    s_sub_u32 s13, s13, 1
    s_add_u32 s3, s59, 12288
    buffer_load_dwordx4 v[80:83], v16, s[4:7], s3 offen offset:2048 sc1
    buffer_load_dwordx4 v[84:87], v16, s[4:7], s3 offen offset:3072 sc1
    s_add_u32 s3, s59, 16384
    buffer_load_dwordx4 v[88:91], v16, s[4:7], s3 offen offset:0 sc1
    buffer_load_dwordx4 v[92:95], v16, s[4:7], s3 offen offset:1024 sc1
    buffer_load_dwordx4 v[96:99], v16, s[4:7], s3 offen offset:2048 sc1
    buffer_load_dwordx4 v[100:103], v16, s[4:7], s3 offen offset:3072 sc1
    s_add_u32 s3, s59, 20480
    buffer_load_dwordx4 v[104:107], v16, s[4:7], s3 offen offset:0 sc1
    buffer_load_dwordx4 v[204:207], v16, s[4:7], s3 offen offset:1024 sc1
    buffer_load_dwordx4 v[208:211], v16, s[4:7], s3 offen offset:2048 sc1
    buffer_load_dwordx4 v[212:215], v16, s[4:7], s3 offen offset:3072 sc1
    s_waitcnt vmcnt(0)
    v_max3_u32 v11, v80, v81, v82
    v_max_u32 v11, v11, v83
    v_cmp_eq_u32 vcc, -1, v11
    s_nop 0
    s_cbranch_vccnz L_hre_97
    s_branch L_hre_ok_98
L_hre_99:
    s_cmp_eq_u32 s13, 0
    s_cbranch_scc1 L_hre_ok_100
    s_sub_u32 s13, s13, 1
    s_add_u32 s3, s59, 12288
    buffer_load_dwordx4 v[84:87], v16, s[4:7], s3 offen offset:3072 sc1
    s_add_u32 s3, s59, 16384
    buffer_load_dwordx4 v[88:91], v16, s[4:7], s3 offen offset:0 sc1
    buffer_load_dwordx4 v[92:95], v16, s[4:7], s3 offen offset:1024 sc1
    buffer_load_dwordx4 v[96:99], v16, s[4:7], s3 offen offset:2048 sc1
    buffer_load_dwordx4 v[100:103], v16, s[4:7], s3 offen offset:3072 sc1
    s_add_u32 s3, s59, 20480
    buffer_load_dwordx4 v[104:107], v16, s[4:7], s3 offen offset:0 sc1
    buffer_load_dwordx4 v[204:207], v16, s[4:7], s3 offen offset:1024 sc1
    buffer_load_dwordx4 v[208:211], v16, s[4:7], s3 offen offset:2048 sc1
    buffer_load_dwordx4 v[212:215], v16, s[4:7], s3 offen offset:3072 sc1
    s_add_u32 s3, s59, 24576
    buffer_load_dwordx4 v[216:219], v16, s[4:7], s3 offen offset:0 sc1
    s_waitcnt vmcnt(0)
    v_max3_u32 v11, v84, v85, v86
    v_max_u32 v11, v11, v87
    v_cmp_eq_u32 vcc, -1, v11
    s_nop 0
    s_cbranch_vccnz L_hre_99
    s_branch L_hre_ok_100
L_hre_101:
    s_cmp_eq_u32 s13, 0
    s_cbranch_scc1 L_hre_ok_102
    s_sub_u32 s13, s13, 1
    s_add_u32 s3, s59, 16384
    buffer_load_dwordx4 v[88:91], v16, s[4:7], s3 offen offset:0 sc1
    buffer_load_dwordx4 v[92:95], v16, s[4:7], s3 offen offset:1024 sc1
    buffer_load_dwordx4 v[96:99], v16, s[4:7], s3 offen offset:2048 sc1
    buffer_load_dwordx4 v[100:103], v16, s[4:7], s3 offen offset:3072 sc1
    s_add_u32 s3, s59, 20480
    buffer_load_dwordx4 v[104:107], v16, s[4:7], s3 offen offset:0 sc1
    buffer_load_dwordx4 v[204:207], v16, s[4:7], s3 offen offset:1024 sc1
    buffer_load_dwordx4 v[208:211], v16, s[4:7], s3 offen offset:2048 sc1
    buffer_load_dwordx4 v[212:215], v16, s[4:7], s3 offen offset:3072 sc1
    s_add_u32 s3, s59, 24576
    buffer_load_dwordx4 v[216:219], v16, s[4:7], s3 offen offset:0 sc1
    buffer_load_dwordx4 v[220:223], v16, s[4:7], s3 offen offset:1024 sc1
    s_waitcnt vmcnt(0)
    v_max3_u32 v11, v88, v89, v90
    v_max_u32 v11, v11, v91
    v_cmp_eq_u32 vcc, -1, v11
    s_nop 0
    s_cbranch_vccnz L_hre_101
    s_branch L_hre_ok_102
L_hre_103:
    s_cmp_eq_u32 s13, 0
    s_cbranch_scc1 L_hre_ok_104
    s_sub_u32 s13, s13, 1
    s_add_u32 s3, s59, 16384
    buffer_load_dwordx4 v[92:95], v16, s[4:7], s3 offen offset:1024 sc1
    buffer_load_dwordx4 v[96:99], v16, s[4:7], s3 offen offset:2048 sc1
    buffer_load_dwordx4 v[100:103], v16, s[4:7], s3 offen offset:3072 sc1
    s_add_u32 s3, s59, 20480
    buffer_load_dwordx4 v[104:107], v16, s[4:7], s3 offen offset:0 sc1
    buffer_load_dwordx4 v[204:207], v16, s[4:7], s3 offen offset:1024 sc1
    buffer_load_dwordx4 v[208:211], v16, s[4:7], s3 offen offset:2048 sc1
    buffer_load_dwordx4 v[212:215], v16, s[4:7], s3 offen offset:3072 sc1
    s_add_u32 s3, s59, 24576
    buffer_load_dwordx4 v[216:219], v16, s[4:7], s3 offen offset:0 sc1
    buffer_load_dwordx4 v[220:223], v16, s[4:7], s3 offen offset:1024 sc1
    buffer_load_dwordx4 v[224:227], v16, s[4:7], s3 offen offset:2048 sc1
    s_waitcnt vmcnt(0)
    v_max3_u32 v11, v92, v93, v94
    v_max_u32 v11, v11, v95
    v_cmp_eq_u32 vcc, -1, v11
    s_nop 0
    s_cbranch_vccnz L_hre_103
    s_branch L_hre_ok_104
L_hre_105:
    s_cmp_eq_u32 s13, 0
    s_cbranch_scc1 L_hre_ok_106
    s_sub_u32 s13, s13, 1
    s_add_u32 s3, s59, 16384
    buffer_load_dwordx4 v[96:99], v16, s[4:7], s3 offen offset:2048 sc1
    buffer_load_dwordx4 v[100:103], v16, s[4:7], s3 offen offset:3072 sc1
    s_add_u32 s3, s59, 20480
    buffer_load_dwordx4 v[104:107], v16, s[4:7], s3 offen offset:0 sc1
    buffer_load_dwordx4 v[204:207], v16, s[4:7], s3 offen offset:1024 sc1
    buffer_load_dwordx4 v[208:211], v16, s[4:7], s3 offen offset:2048 sc1
    buffer_load_dwordx4 v[212:215], v16, s[4:7], s3 offen offset:3072 sc1
    s_add_u32 s3, s59, 24576
    buffer_load_dwordx4 v[216:219], v16, s[4:7], s3 offen offset:0 sc1
    buffer_load_dwordx4 v[220:223], v16, s[4:7], s3 offen offset:1024 sc1
    buffer_load_dwordx4 v[224:227], v16, s[4:7], s3 offen offset:2048 sc1
    buffer_load_dwordx4 v[228:231], v16, s[4:7], s3 offen offset:3072 sc1
    s_waitcnt vmcnt(0)
    v_max3_u32 v11, v96, v97, v98
    v_max_u32 v11, v11, v99
    v_cmp_eq_u32 vcc, -1, v11
    s_nop 0
    s_cbranch_vccnz L_hre_105
    s_branch L_hre_ok_106
L_hre_107:
    s_cmp_eq_u32 s13, 0
    s_cbranch_scc1 L_hre_ok_108
    s_sub_u32 s13, s13, 1
    s_add_u32 s3, s59, 16384
    buffer_load_dwordx4 v[100:103], v16, s[4:7], s3 offen offset:3072 sc1
    s_add_u32 s3, s59, 20480
    buffer_load_dwordx4 v[104:107], v16, s[4:7], s3 offen offset:0 sc1
    buffer_load_dwordx4 v[204:207], v16, s[4:7], s3 offen offset:1024 sc1
    buffer_load_dwordx4 v[208:211], v16, s[4:7], s3 offen offset:2048 sc1
    buffer_load_dwordx4 v[212:215], v16, s[4:7], s3 offen offset:3072 sc1
    s_add_u32 s3, s59, 24576
    buffer_load_dwordx4 v[216:219], v16, s[4:7], s3 offen offset:0 sc1
    buffer_load_dwordx4 v[220:223], v16, s[4:7], s3 offen offset:1024 sc1
    buffer_load_dwordx4 v[224:227], v16, s[4:7], s3 offen offset:2048 sc1
    buffer_load_dwordx4 v[228:231], v16, s[4:7], s3 offen offset:3072 sc1
    s_waitcnt vmcnt(0)
    v_max3_u32 v11, v100, v101, v102
    v_max_u32 v11, v11, v103
    v_cmp_eq_u32 vcc, -1, v11
    s_nop 0
    s_cbranch_vccnz L_hre_107
    s_branch L_hre_ok_108
L_hre_109:
    s_cmp_eq_u32 s13, 0
    s_cbranch_scc1 L_hre_ok_110
    s_sub_u32 s13, s13, 1
    s_add_u32 s3, s59, 20480
    buffer_load_dwordx4 v[104:107], v16, s[4:7], s3 offen offset:0 sc1
    buffer_load_dwordx4 v[204:207], v16, s[4:7], s3 offen offset:1024 sc1
    buffer_load_dwordx4 v[208:211], v16, s[4:7], s3 offen offset:2048 sc1
    buffer_load_dwordx4 v[212:215], v16, s[4:7], s3 offen offset:3072 sc1
    s_add_u32 s3, s59, 24576
    buffer_load_dwordx4 v[216:219], v16, s[4:7], s3 offen offset:0 sc1
    buffer_load_dwordx4 v[220:223], v16, s[4:7], s3 offen offset:1024 sc1
    buffer_load_dwordx4 v[224:227], v16, s[4:7], s3 offen offset:2048 sc1
    buffer_load_dwordx4 v[228:231], v16, s[4:7], s3 offen offset:3072 sc1
    s_waitcnt vmcnt(0)
    v_max3_u32 v11, v104, v105, v106
    v_max_u32 v11, v11, v107
    v_cmp_eq_u32 vcc, -1, v11
    s_nop 0
    s_cbranch_vccnz L_hre_109
    s_branch L_hre_ok_110
L_hre_111:
    s_cmp_eq_u32 s13, 0
    s_cbranch_scc1 L_hre_ok_112
    s_sub_u32 s13, s13, 1
    s_add_u32 s3, s59, 20480
    buffer_load_dwordx4 v[204:207], v16, s[4:7], s3 offen offset:1024 sc1
    buffer_load_dwordx4 v[208:211], v16, s[4:7], s3 offen offset:2048 sc1
    buffer_load_dwordx4 v[212:215], v16, s[4:7], s3 offen offset:3072 sc1
    s_add_u32 s3, s59, 24576
    buffer_load_dwordx4 v[216:219], v16, s[4:7], s3 offen offset:0 sc1
    buffer_load_dwordx4 v[220:223], v16, s[4:7], s3 offen offset:1024 sc1
    buffer_load_dwordx4 v[224:227], v16, s[4:7], s3 offen offset:2048 sc1
    buffer_load_dwordx4 v[228:231], v16, s[4:7], s3 offen offset:3072 sc1
    s_waitcnt vmcnt(0)
    v_max3_u32 v11, v204, v205, v206
    v_max_u32 v11, v11, v207
    v_cmp_eq_u32 vcc, -1, v11
    s_nop 0
    s_cbranch_vccnz L_hre_111
    s_branch L_hre_ok_112
L_hre_113:
    s_cmp_eq_u32 s13, 0
    s_cbranch_scc1 L_hre_ok_114
    s_sub_u32 s13, s13, 1
    s_add_u32 s3, s59, 20480
    buffer_load_dwordx4 v[208:211], v16, s[4:7], s3 offen offset:2048 sc1
    buffer_load_dwordx4 v[212:215], v16, s[4:7], s3 offen offset:3072 sc1
    s_add_u32 s3, s59, 24576
    buffer_load_dwordx4 v[216:219], v16, s[4:7], s3 offen offset:0 sc1
    buffer_load_dwordx4 v[220:223], v16, s[4:7], s3 offen offset:1024 sc1
    buffer_load_dwordx4 v[224:227], v16, s[4:7], s3 offen offset:2048 sc1
    buffer_load_dwordx4 v[228:231], v16, s[4:7], s3 offen offset:3072 sc1
    s_waitcnt vmcnt(0)
    v_max3_u32 v11, v208, v209, v210
    v_max_u32 v11, v11, v211
    v_cmp_eq_u32 vcc, -1, v11
    s_nop 0
    s_cbranch_vccnz L_hre_113
    s_branch L_hre_ok_114
L_hre_115:
    s_cmp_eq_u32 s13, 0
    s_cbranch_scc1 L_hre_ok_116
    s_sub_u32 s13, s13, 1
    s_add_u32 s3, s59, 20480
    buffer_load_dwordx4 v[212:215], v16, s[4:7], s3 offen offset:3072 sc1
    s_add_u32 s3, s59, 24576
    buffer_load_dwordx4 v[216:219], v16, s[4:7], s3 offen offset:0 sc1
    buffer_load_dwordx4 v[220:223], v16, s[4:7], s3 offen offset:1024 sc1
    buffer_load_dwordx4 v[224:227], v16, s[4:7], s3 offen offset:2048 sc1
    buffer_load_dwordx4 v[228:231], v16, s[4:7], s3 offen offset:3072 sc1
    s_waitcnt vmcnt(0)
    v_max3_u32 v11, v212, v213, v214
    v_max_u32 v11, v11, v215
    v_cmp_eq_u32 vcc, -1, v11
    s_nop 0
    s_cbranch_vccnz L_hre_115
    s_branch L_hre_ok_116
L_hre_117:
    s_cmp_eq_u32 s13, 0
    s_cbranch_scc1 L_hre_ok_118
    s_sub_u32 s13, s13, 1
    s_add_u32 s3, s59, 24576
    buffer_load_dwordx4 v[216:219], v16, s[4:7], s3 offen offset:0 sc1
    buffer_load_dwordx4 v[220:223], v16, s[4:7], s3 offen offset:1024 sc1
    buffer_load_dwordx4 v[224:227], v16, s[4:7], s3 offen offset:2048 sc1
    buffer_load_dwordx4 v[228:231], v16, s[4:7], s3 offen offset:3072 sc1
    s_waitcnt vmcnt(0)
    v_max3_u32 v11, v216, v217, v218
    v_max_u32 v11, v11, v219
    v_cmp_eq_u32 vcc, -1, v11
    s_nop 0
    s_cbranch_vccnz L_hre_117
    s_branch L_hre_ok_118
L_hre_119:
    s_cmp_eq_u32 s13, 0
    s_cbranch_scc1 L_hre_ok_120
    s_sub_u32 s13, s13, 1
    s_add_u32 s3, s59, 24576
    buffer_load_dwordx4 v[220:223], v16, s[4:7], s3 offen offset:1024 sc1
    buffer_load_dwordx4 v[224:227], v16, s[4:7], s3 offen offset:2048 sc1
    buffer_load_dwordx4 v[228:231], v16, s[4:7], s3 offen offset:3072 sc1
    s_waitcnt vmcnt(0)
    v_max3_u32 v11, v220, v221, v222
    v_max_u32 v11, v11, v223
    v_cmp_eq_u32 vcc, -1, v11
    s_nop 0
    s_cbranch_vccnz L_hre_119
    s_branch L_hre_ok_120
L_hre_121:
    s_cmp_eq_u32 s13, 0
    s_cbranch_scc1 L_hre_ok_122
    s_sub_u32 s13, s13, 1
    s_add_u32 s3, s59, 24576
    buffer_load_dwordx4 v[224:227], v16, s[4:7], s3 offen offset:2048 sc1
    buffer_load_dwordx4 v[228:231], v16, s[4:7], s3 offen offset:3072 sc1
    s_waitcnt vmcnt(0)
    v_max3_u32 v11, v224, v225, v226
    v_max_u32 v11, v11, v227
    v_cmp_eq_u32 vcc, -1, v11
    s_nop 0
    s_cbranch_vccnz L_hre_121
    s_branch L_hre_ok_122
L_hre_123:
    s_cmp_eq_u32 s13, 0
    s_cbranch_scc1 L_hre_ok_124
    s_sub_u32 s13, s13, 1
    s_add_u32 s3, s59, 24576
    buffer_load_dwordx4 v[228:231], v16, s[4:7], s3 offen offset:3072 sc1
    s_waitcnt vmcnt(0)
    v_max3_u32 v11, v228, v229, v230
    v_max_u32 v11, v11, v231
    v_cmp_eq_u32 vcc, -1, v11
    s_nop 0
    s_cbranch_vccnz L_hre_123
    s_branch L_hre_ok_124
.section .rodata,"a"
.p2align 6
.amdhsa_kernel sequential_preLN__spectral_gfnet__glu_gated_bilinear__prompt_kernel
  .amdhsa_next_free_vgpr 512
  .amdhsa_next_free_sgpr 102
  .amdhsa_accum_offset 256
  .amdhsa_group_segment_fixed_size 0
  .amdhsa_kernarg_size 80
  .amdhsa_user_sgpr_count 2
  .amdhsa_user_sgpr_kernarg_segment_ptr 1
  .amdhsa_system_sgpr_workgroup_id_x 1
.end_amdhsa_kernel
```
